```python
import torch

def _softmax(x, axis=-1):
    return torch.softmax(x, dim=axis)

def _gelu(x):
    return torch.nn.functional.gelu(x, approximate='tanh')

def _silu(x):
    return torch.nn.functional.silu(x)

def _sigmoid(x):
    return torch.sigmoid(x)

def _layernorm(x, axis=-1, eps=1e-05):
    m = x.mean(dim=axis, keepdim=True)
    v = x.var(dim=axis, keepdim=True, unbiased=False)
    return (x - m) / torch.sqrt(v + eps)

def _scatter_add(tgt, idx, src, axis=0):
    return tgt.clone().index_add_(axis, idx, src)

def _segment_sum(src, seg, n):
    out = torch.zeros((n,) + src.shape[1:], dtype=src.dtype)
    return out.index_add_(0, seg, src)

def _pad(x, pw):
    flat = tuple((v for pair in reversed(pw) for v in pair))
    return torch.nn.functional.pad(x, flat)
kernel_name = 'adaLN_cond__gqa_block_cached__geglu_ffn__decode'

def setup_inputs():

    _w = lambda a: (lambda t: t.to(torch.bfloat16) if t.is_floating_point() else t)(torch.as_tensor(a))

    def _A_setup():
        B, Sq, D = (4, 1, 448)
        Hq, Hkv, Sk, Dh = (16, 8, 4096, 256)
        assert Hq % Hkv == 0, (Hq, Hkv)
        return {'x': _w((lambda *s: torch.randn(*s, dtype=torch.bfloat16) * 0.05)(B, Sq, D)), 'k_cache': _w((lambda *s: torch.randn(*s, dtype=torch.bfloat16) * 3.2)(B, Hkv, Sk, Dh)), 'v_cache': _w((lambda *s: torch.randn(*s, dtype=torch.bfloat16) * 0.4)(B, Hkv, Sk, Dh)), 'wq': _w((lambda *s: torch.randn(*s, dtype=torch.bfloat16) * 3.2)(D, Hq * Dh) * D ** (-0.5)), 'wo': _w((lambda *s: torch.randn(*s, dtype=torch.bfloat16) * 0.4)(Hq * Dh, D) * (Hq * Dh) ** (-0.5))}
    _A_in = _A_setup()

    def _B_setup():
        B, S, D, F = (4, 1, 448, 1792)
        return {'x': _w((lambda *s: torch.randn(*s, dtype=torch.bfloat16) * 0.05)(B, S, D)), 'w_gate': _w((lambda *s: torch.randn(*s, dtype=torch.bfloat16) * 0.05)(D, F)), 'w_up': _w((lambda *s: torch.randn(*s, dtype=torch.bfloat16) * 0.05)(D, F)), 'w_down': _w((lambda *s: torch.randn(*s, dtype=torch.bfloat16) * 0.05)(F, D))}
    _B_in = _B_setup()
    return {'A_x': _A_in['x'], 'A_k_cache': _A_in['k_cache'], 'A_v_cache': _A_in['v_cache'], 'A_wq': _A_in['wq'], 'A_wo': _A_in['wo'], 'B_x': _B_in['x'], 'B_w_gate': _B_in['w_gate'], 'B_w_up': _B_in['w_up'], 'B_w_down': _B_in['w_down'], 'c': _w((lambda *s: torch.randn(*s, dtype=torch.bfloat16) * 0.2)(4, 448) * 8.0), 'w_mod': _w((lambda *s: torch.randn(*s, dtype=torch.bfloat16) * 0.2)(448, 6 * 448) * 448 ** (-0.5) * 8.0)}

def reference(A_x, A_k_cache, A_v_cache, A_wq, A_wo, B_x, B_w_gate, B_w_up, B_w_down, c, w_mod):

    def _A_ref(x, k_cache, v_cache, wq, wo):
        B, Sq, D = x.shape
        Hq, Dh = (16, 256)
        Hkv = k_cache.shape[1]
        rep = Hq // Hkv
        q = (lambda x, *d: x.permute(*d))((x @ wq).reshape(B, Sq, Hq, Dh), 0, 2, 1, 3)
        k = (lambda x, n, axis: torch.repeat_interleave(x, n, dim=axis))(k_cache, rep, axis=1)
        v = (lambda x, n, axis: torch.repeat_interleave(x, n, dim=axis))(v_cache, rep, axis=1)
        scores = torch.einsum('bhqd,bhkd->bhqk', q, k) * Dh ** (-0.5)
        p = _softmax(scores, axis=-1)
        o = torch.einsum('bhqk,bhkd->bhqd', p, v)
        return (lambda x, *d: x.permute(*d))(o, 0, 2, 1, 3).reshape(B, Sq, Hq * Dh) @ wo

    def _B_ref(x, w_gate, w_up, w_down):
        return _gelu(x @ w_gate) * (x @ w_up) @ w_down
    x = A_x
    mod = (_silu(c) @ w_mod).reshape(c.shape[0], 6, 1, -1)
    sa, ca, ga, sb, cb, gb = (mod[:, 0].clone(), mod[:, 1].clone(), mod[:, 2].clone(), mod[:, 3].clone(), mod[:, 4].clone(), mod[:, 5].clone())
    h = _layernorm(x, axis=-1) * (1 + ca) + sa
    x = x + ga * _A_ref(h, A_k_cache, A_v_cache, A_wq, A_wo)
    h = _layernorm(x, axis=-1) * (1 + cb) + sb
    x = x + gb * _B_ref(h, B_w_gate, B_w_up, B_w_down)
    return x
```

```asm
; @launch grid=(256,1,1) block=(512,1,1) lds=155136
.amdgcn_target "amdgcn-amd-amdhsa--gfx950"
.text
.globl adaLN_cond__gqa_block_cached__geglu_ffn__decode_kernel
.p2align 8
.type adaLN_cond__gqa_block_cached__geglu_ffn__decode_kernel,@function
adaLN_cond__gqa_block_cached__geglu_ffn__decode_kernel:
    s_cmp_ge_u32 s2, 256
    s_cbranch_scc1 L_end
    s_load_dwordx16 s[16:31], s[0:1], 0
    s_load_dwordx8 s[32:39], s[0:1], 64
    s_load_dwordx4 s[40:43], s[0:1], 96
    v_lshrrev_b32 v3, 6, v0
    v_and_b32 v0, 63, v0
    v_readfirstlane_b32 s3, v3
    v_lshrrev_b32 v1, 4, v0
    v_and_b32 v2, 15, v0
    s_lshr_b32 s4, s2, 3
    s_and_b32 s5, s2, 7
    s_lshr_b32 s6, s2, 6
    s_and_b32 s7, s4, 7
    s_mov_b32 s12, 0x05040100
    s_mov_b32 s13, 0x07060302
    s_mov_b32 s14, 0x3db8aa3b
    s_cmp_eq_u32 s5, 7
    s_cbranch_scc1 L_sx
    s_lshr_b32 s8, s4, 1
    s_add_u32 s98, s8, s5
    s_sub_u32 s9, s98, 7
    s_cmp_ge_u32 s98, 7
    s_cselect_b32 s98, s9, s98
    s_sub_u32 s9, s98, 7
    s_cmp_ge_u32 s98, 7
    s_cselect_b32 s98, s9, s98
    s_sub_u32 s9, s98, 7
    s_cmp_ge_u32 s98, 7
    s_cselect_b32 s98, s9, s98
    s_cmp_ge_u32 s4, 28
    s_cselect_b32 s98, 7, s98
    s_cmp_eq_u32 s2, 248
    s_cbranch_scc1 L_reset
L_st0:
    s_cmp_lt_u32 s3, 2
    s_cbranch_scc1 L_helper
    s_sub_u32 s8, s3, 2
    s_lshl_b32 s101, s8, 15
    s_mul_i32 s9, s5, 4
    s_add_u32 s10, s9, s8
    s_add_u32 s99, s10, 4294967226
    s_add_u32 s97, s10, 4294967254
    s_cmp_lt_u32 s3, 6
    s_cbranch_scc1 L_st2
    s_sub_u32 s8, s3, 6
    s_lshl_b32 s101, s8, 13
    s_add_u32 s101, s101, 131072
    s_mul_i32 s8, s8, 3
    s_mul_i32 s9, s5, 6
    s_add_u32 s10, s9, s8
    s_add_u32 s10, s10, 168
L_st2:
    v_lshrrev_b32 v21, 5, v0
    v_and_b32 v22, 31, v0
    v_xor_b32 v22, v22, v21
    v_lshlrev_b32 v22, 4, v22
    v_lshl_add_u32 v4, v21, 9, v22
    v_xor_b32 v5, 32, v4
    v_xor_b32 v6, 64, v4
    v_xor_b32 v7, 96, v4
    v_xor_b32 v8, 4224, v4
    v_xor_b32 v9, 4256, v4
    v_xor_b32 v10, 4288, v4
    v_xor_b32 v11, 4320, v4
    v_lshlrev_b32 v21, 4, v2
    v_lshl_add_u32 v12, v1, 11, v21
    s_lshl_b32 s11, s4, 21
    s_mov_b32 s59, s11
    s_lshl_b32 s10, s10, 13
    s_add_u32 s10, s10, s11
    s_waitcnt lgkmcnt(0)
    s_mov_b32 s44, s18
    s_mov_b32 s45, s19
    s_mov_b32 s46, 67108864
    s_mov_b32 s47, 0x20000
    s_mov_b32 s48, s20
    s_mov_b32 s49, s21
    s_mov_b32 s50, 67108864
    s_mov_b32 s51, 0x20000
    s_cmp_ge_u32 s3, 6
    s_cbranch_scc1 L_extra
    s_add_u32 m0, s101, 0
    s_waitcnt vmcnt(5)
    buffer_load_dwordx4 v4, s[44:47], s10 offen offset:0 nt lds
    s_add_u32 m0, s101, 4096
    s_waitcnt vmcnt(5)
    buffer_load_dwordx4 v8, s[44:47], s10 offen offset:0 nt lds
    s_add_u32 m0, s101, 0
    s_waitcnt vmcnt(5)
    buffer_load_dwordx4 v5, s[44:47], s10 offen offset:1024 nt lds
    s_add_u32 m0, s101, 4096
    s_waitcnt vmcnt(5)
    buffer_load_dwordx4 v9, s[44:47], s10 offen offset:1024 nt lds
    s_add_u32 m0, s101, 0
    s_waitcnt vmcnt(5)
    buffer_load_dwordx4 v6, s[44:47], s10 offen offset:2048 nt lds
    s_add_u32 m0, s101, 4096
    s_waitcnt vmcnt(5)
    buffer_load_dwordx4 v10, s[44:47], s10 offen offset:2048 nt lds
    s_add_u32 m0, s101, 0
    s_waitcnt vmcnt(5)
    buffer_load_dwordx4 v7, s[44:47], s10 offen offset:3072 nt lds
    s_add_u32 m0, s101, 4096
    s_waitcnt vmcnt(5)
    buffer_load_dwordx4 v11, s[44:47], s10 offen offset:3072 nt lds
    s_barrier
    s_mov_b32 s52, s42
    s_mov_b32 s53, s43
    s_mov_b32 s54, 1310720
    s_mov_b32 s55, 0x20000
    s_lshl_b32 s9, s4, 10
    s_add_u32 s9, s9, 65536
    s_add_u32 s56, s42, s9
    s_addc_u32 s57, s43, 0
    v_mov_b32 v22, v2
    v_xor_b32 v21, v1, v22
    v_lshlrev_b32 v21, 4, v21
    v_lshl_add_u32 v21, v22, 9, v21
    v_add_u32 v13, s101, v21
    v_xor_b32 v14, 64, v13
    v_xor_b32 v15, 128, v13
    v_xor_b32 v16, 192, v13
    v_lshrrev_b32 v21, 1, v2
    v_cmp_eq_u32 s[64:65], 0, v21
    v_cmp_eq_u32 s[66:67], 1, v21
    v_cmp_eq_u32 s[68:69], 2, v21
    v_cmp_eq_u32 s[70:71], 3, v21
    v_cmp_eq_u32 s[72:73], 4, v21
    v_cmp_eq_u32 s[74:75], 5, v21
    v_cmp_eq_u32 s[76:77], 6, v21
    v_cmp_eq_u32 s[78:79], 7, v21
    v_mov_b32 v17, 0xff800000
    v_mov_b32 v18, 0
    v_mov_b32 v32, 0
    v_mov_b32 v33, 0
    v_mov_b32 v34, 0
    v_mov_b32 v35, 0
    v_mov_b32 v36, 0
    v_mov_b32 v37, 0
    v_mov_b32 v38, 0
    v_mov_b32 v39, 0
    s_add_u32 s10, s10, 229376
    s_add_u32 m0, s101, 8192
    s_waitcnt vmcnt(5)
    buffer_load_dwordx4 v4, s[44:47], s10 offen offset:0 nt lds
    s_add_u32 m0, s101, 12288
    s_waitcnt vmcnt(5)
    buffer_load_dwordx4 v8, s[44:47], s10 offen offset:0 nt lds
    s_add_u32 m0, s101, 8192
    s_waitcnt vmcnt(5)
    buffer_load_dwordx4 v5, s[44:47], s10 offen offset:1024 nt lds
    s_add_u32 m0, s101, 12288
    s_waitcnt vmcnt(5)
    buffer_load_dwordx4 v9, s[44:47], s10 offen offset:1024 nt lds
    s_add_u32 m0, s101, 8192
    s_waitcnt vmcnt(5)
    buffer_load_dwordx4 v6, s[44:47], s10 offen offset:2048 nt lds
    s_add_u32 m0, s101, 12288
    s_waitcnt vmcnt(5)
    buffer_load_dwordx4 v10, s[44:47], s10 offen offset:2048 nt lds
    s_add_u32 m0, s101, 8192
    s_waitcnt vmcnt(5)
    buffer_load_dwordx4 v7, s[44:47], s10 offen offset:3072 nt lds
    s_add_u32 m0, s101, 12288
    s_waitcnt vmcnt(5)
    buffer_load_dwordx4 v11, s[44:47], s10 offen offset:3072 nt lds
    s_add_u32 s10, s10, 229376
    s_add_u32 m0, s101, 16384
    s_waitcnt vmcnt(5)
    buffer_load_dwordx4 v4, s[44:47], s10 offen offset:0 nt lds
    s_add_u32 m0, s101, 20480
    s_waitcnt vmcnt(5)
    buffer_load_dwordx4 v8, s[44:47], s10 offen offset:0 nt lds
    s_add_u32 m0, s101, 16384
    s_waitcnt vmcnt(5)
    buffer_load_dwordx4 v5, s[44:47], s10 offen offset:1024 nt lds
    s_add_u32 m0, s101, 20480
    s_waitcnt vmcnt(5)
    buffer_load_dwordx4 v9, s[44:47], s10 offen offset:1024 nt lds
    s_add_u32 m0, s101, 16384
    s_waitcnt vmcnt(5)
    buffer_load_dwordx4 v6, s[44:47], s10 offen offset:2048 nt lds
    s_add_u32 m0, s101, 20480
    s_waitcnt vmcnt(5)
    buffer_load_dwordx4 v10, s[44:47], s10 offen offset:2048 nt lds
    s_add_u32 m0, s101, 16384
    s_waitcnt vmcnt(5)
    buffer_load_dwordx4 v7, s[44:47], s10 offen offset:3072 nt lds
    s_add_u32 m0, s101, 20480
    s_waitcnt vmcnt(5)
    buffer_load_dwordx4 v11, s[44:47], s10 offen offset:3072 nt lds
    s_add_u32 s10, s10, 229376
    s_add_u32 m0, s101, 24576
    s_waitcnt vmcnt(5)
    buffer_load_dwordx4 v4, s[44:47], s10 offen offset:0 nt lds
    s_add_u32 m0, s101, 28672
    s_waitcnt vmcnt(5)
    buffer_load_dwordx4 v8, s[44:47], s10 offen offset:0 nt lds
    s_add_u32 m0, s101, 24576
    s_waitcnt vmcnt(5)
    buffer_load_dwordx4 v5, s[44:47], s10 offen offset:1024 nt lds
    s_add_u32 m0, s101, 28672
    s_waitcnt vmcnt(5)
    buffer_load_dwordx4 v9, s[44:47], s10 offen offset:1024 nt lds
    s_add_u32 m0, s101, 24576
    s_waitcnt vmcnt(5)
    buffer_load_dwordx4 v6, s[44:47], s10 offen offset:2048 nt lds
    s_add_u32 m0, s101, 28672
    s_waitcnt vmcnt(5)
    buffer_load_dwordx4 v10, s[44:47], s10 offen offset:2048 nt lds
    s_add_u32 m0, s101, 24576
    s_waitcnt vmcnt(5)
    buffer_load_dwordx4 v7, s[44:47], s10 offen offset:3072 nt lds
    s_add_u32 m0, s101, 28672
    s_waitcnt vmcnt(5)
    buffer_load_dwordx4 v11, s[44:47], s10 offen offset:3072 nt lds
    s_add_u32 s10, s10, 229376
    s_waitcnt vmcnt(5)
    buffer_load_dwordx4 v[224:227], v4, s[44:47], s10 offen offset:0 nt
    s_waitcnt vmcnt(5)
    buffer_load_dwordx4 v[240:243], v8, s[44:47], s10 offen offset:0 nt
    s_waitcnt vmcnt(5)
    buffer_load_dwordx4 v[228:231], v5, s[44:47], s10 offen offset:1024 nt
    s_waitcnt vmcnt(5)
    buffer_load_dwordx4 v[244:247], v9, s[44:47], s10 offen offset:1024 nt
    s_waitcnt vmcnt(5)
    buffer_load_dwordx4 v[232:235], v6, s[44:47], s10 offen offset:2048 nt
    s_waitcnt vmcnt(5)
    buffer_load_dwordx4 v[248:251], v10, s[44:47], s10 offen offset:2048 nt
    s_waitcnt vmcnt(5)
    buffer_load_dwordx4 v[236:239], v7, s[44:47], s10 offen offset:3072 nt
    s_waitcnt vmcnt(5)
    buffer_load_dwordx4 v[252:255], v11, s[44:47], s10 offen offset:3072 nt
    s_sub_u32 s10, s10, 917504
    s_waitcnt vmcnt(5)
    buffer_load_dwordx4 v[96:99], v12, s[48:51], s10 offen offset:0 nt
    s_waitcnt vmcnt(5)
    buffer_load_dwordx4 v[100:103], v12, s[48:51], s10 offen offset:512 nt
    s_waitcnt vmcnt(5)
    buffer_load_dwordx4 v[104:107], v12, s[48:51], s10 offen offset:1024 nt
    s_waitcnt vmcnt(5)
    buffer_load_dwordx4 v[108:111], v12, s[48:51], s10 offen offset:1536 nt
    s_waitcnt vmcnt(5)
    buffer_load_dwordx4 v[112:115], v12, s[48:51], s10 offen offset:256 nt
    s_waitcnt vmcnt(5)
    buffer_load_dwordx4 v[116:119], v12, s[48:51], s10 offen offset:768 nt
    s_waitcnt vmcnt(5)
    buffer_load_dwordx4 v[120:123], v12, s[48:51], s10 offen offset:1280 nt
    s_waitcnt vmcnt(5)
    buffer_load_dwordx4 v[124:127], v12, s[48:51], s10 offen offset:1792 nt
    s_add_u32 s10, s10, 229376
    s_waitcnt vmcnt(5)
    buffer_load_dwordx4 v[128:131], v12, s[48:51], s10 offen offset:0 nt
    s_waitcnt vmcnt(5)
    buffer_load_dwordx4 v[132:135], v12, s[48:51], s10 offen offset:512 nt
    s_waitcnt vmcnt(5)
    buffer_load_dwordx4 v[136:139], v12, s[48:51], s10 offen offset:1024 nt
    s_waitcnt vmcnt(5)
    buffer_load_dwordx4 v[140:143], v12, s[48:51], s10 offen offset:1536 nt
    s_waitcnt vmcnt(5)
    buffer_load_dwordx4 v[144:147], v12, s[48:51], s10 offen offset:256 nt
    s_waitcnt vmcnt(5)
    buffer_load_dwordx4 v[148:151], v12, s[48:51], s10 offen offset:768 nt
    s_waitcnt vmcnt(5)
    buffer_load_dwordx4 v[152:155], v12, s[48:51], s10 offen offset:1280 nt
    s_waitcnt vmcnt(5)
    buffer_load_dwordx4 v[156:159], v12, s[48:51], s10 offen offset:1792 nt
    s_add_u32 s10, s10, 229376
    s_waitcnt vmcnt(5)
    buffer_load_dwordx4 v[160:163], v12, s[48:51], s10 offen offset:0 nt
    s_waitcnt vmcnt(5)
    buffer_load_dwordx4 v[164:167], v12, s[48:51], s10 offen offset:512 nt
    s_waitcnt vmcnt(5)
    buffer_load_dwordx4 v[168:171], v12, s[48:51], s10 offen offset:1024 nt
    s_waitcnt vmcnt(5)
    buffer_load_dwordx4 v[172:175], v12, s[48:51], s10 offen offset:1536 nt
    s_waitcnt vmcnt(5)
    buffer_load_dwordx4 v[176:179], v12, s[48:51], s10 offen offset:256 nt
    s_waitcnt vmcnt(5)
    buffer_load_dwordx4 v[180:183], v12, s[48:51], s10 offen offset:768 nt
    s_waitcnt vmcnt(5)
    buffer_load_dwordx4 v[184:187], v12, s[48:51], s10 offen offset:1280 nt
    s_waitcnt vmcnt(5)
    buffer_load_dwordx4 v[188:191], v12, s[48:51], s10 offen offset:1792 nt
    s_add_u32 s10, s10, 229376
    s_waitcnt vmcnt(5)
    buffer_load_dwordx4 v[192:195], v12, s[48:51], s10 offen offset:0 nt
    s_waitcnt vmcnt(5)
    buffer_load_dwordx4 v[196:199], v12, s[48:51], s10 offen offset:512 nt
    s_waitcnt vmcnt(5)
    buffer_load_dwordx4 v[200:203], v12, s[48:51], s10 offen offset:1024 nt
    s_waitcnt vmcnt(5)
    buffer_load_dwordx4 v[204:207], v12, s[48:51], s10 offen offset:1536 nt
    s_waitcnt vmcnt(5)
    buffer_load_dwordx4 v[208:211], v12, s[48:51], s10 offen offset:256 nt
    s_waitcnt vmcnt(5)
    buffer_load_dwordx4 v[212:215], v12, s[48:51], s10 offen offset:768 nt
    s_waitcnt vmcnt(5)
    buffer_load_dwordx4 v[216:219], v12, s[48:51], s10 offen offset:1280 nt
    s_waitcnt vmcnt(5)
    buffer_load_dwordx4 v[220:223], v12, s[48:51], s10 offen offset:1792 nt
    s_add_u32 s10, s10, 229376
    v_and_b32 v21, 1, v2
    v_lshlrev_b32 v21, 9, v21
    v_lshl_add_u32 v21, v1, 4, v21
    v_add_u32 v21, 147456, v21
    v_mov_b32 v22, 148480
    s_mov_b32 s15, 0
L_qw1:
    ds_read_b32 v19, v22
    s_waitcnt lgkmcnt(0)
    v_cmp_eq_u32 vcc, 0, v19
    s_nop 0
    s_cbranch_vccz L_qw1_ok
    s_sleep 2
    s_add_u32 s15, s15, 1
    s_cmp_lt_u32 s15, 16000000
    s_cbranch_scc1 L_qw1
L_qw1_ok:
    ds_read_b128 v[64:67], v21 offset:0
    ds_read_b128 v[68:71], v21 offset:64
    ds_read_b128 v[72:75], v21 offset:128
    ds_read_b128 v[76:79], v21 offset:192
    ds_read_b128 v[80:83], v21 offset:256
    ds_read_b128 v[84:87], v21 offset:320
    ds_read_b128 v[88:91], v21 offset:384
    ds_read_b128 v[92:95], v21 offset:448
    s_waitcnt lgkmcnt(0)
    ds_read_b128 v[40:43], v13 offset:0
    ds_read_b128 v[44:47], v14 offset:0
    ds_read_b128 v[48:51], v15 offset:0
    ds_read_b128 v[52:55], v16 offset:0
    s_waitcnt lgkmcnt(3)
    v_mfma_f32_16x16x32_bf16 v[24:27], v[40:43], v[64:67], 0
    ds_read_b128 v[40:43], v13 offset:256
    s_waitcnt lgkmcnt(3)
    v_mfma_f32_16x16x32_bf16 v[24:27], v[44:47], v[68:71], v[24:27]
    ds_read_b128 v[44:47], v14 offset:256
    s_waitcnt lgkmcnt(3)
    v_mfma_f32_16x16x32_bf16 v[24:27], v[48:51], v[72:75], v[24:27]
    ds_read_b128 v[48:51], v15 offset:256
    s_waitcnt lgkmcnt(3)
    v_mfma_f32_16x16x32_bf16 v[24:27], v[52:55], v[76:79], v[24:27]
    ds_read_b128 v[52:55], v16 offset:256
    s_waitcnt lgkmcnt(3)
    v_mfma_f32_16x16x32_bf16 v[24:27], v[40:43], v[80:83], v[24:27]
    s_waitcnt lgkmcnt(2)
    v_mfma_f32_16x16x32_bf16 v[24:27], v[44:47], v[84:87], v[24:27]
    s_waitcnt lgkmcnt(1)
    v_mfma_f32_16x16x32_bf16 v[24:27], v[48:51], v[88:91], v[24:27]
    s_waitcnt lgkmcnt(0)
    v_mfma_f32_16x16x32_bf16 v[24:27], v[52:55], v[92:95], v[24:27]
    s_nop 7
    v_cvt_pk_bf16_f32 v28, 0, v24
    v_cvt_pk_bf16_f32 v29, 0, v25
    v_cvt_pk_bf16_f32 v30, 0, v26
    v_cvt_pk_bf16_f32 v31, 0, v27
    v_max3_f32 v21, v28, v29, v30
    v_max3_f32 v21, v21, v31, v17
    v_mov_b32 v22, v21
    s_nop 1
    v_permlane32_swap_b32 v21, v22
    v_max_f32 v21, v21, v22
    v_mov_b32 v22, v21
    s_nop 1
    v_permlane16_swap_b32 v21, v22
    v_max_f32 v21, v21, v22
    v_sub_f32 v19, v17, v21
    v_sub_f32 v28, v28, v21
    v_sub_f32 v29, v29, v21
    v_sub_f32 v30, v30, v21
    v_sub_f32 v31, v31, v21
    v_mul_f32 v19, s14, v19
    v_mul_f32 v28, s14, v28
    v_mul_f32 v29, s14, v29
    v_mul_f32 v30, s14, v30
    v_mul_f32 v31, s14, v31
    v_exp_f32 v19, v19
    v_exp_f32 v28, v28
    v_exp_f32 v29, v29
    v_exp_f32 v30, v30
    v_exp_f32 v31, v31
    v_mov_b32 v17, v21
    v_cvt_pk_bf16_f32 v24, v28, v29
    v_cvt_pk_bf16_f32 v25, v30, v31
    v_add_f32 v21, v28, v29
    v_add_f32 v22, v30, v31
    v_add_f32 v21, v21, v22
    v_fma_f32 v18, v18, v19, v21
    v_mul_f32_dpp v32, v19, v32 quad_perm:[0,0,2,2] row_mask:0xf bank_mask:0xf
    v_mul_f32_dpp v33, v19, v33 quad_perm:[1,1,3,3] row_mask:0xf bank_mask:0xf
    v_mul_f32_dpp v34, v19, v34 quad_perm:[0,0,2,2] row_mask:0xf bank_mask:0xf
    v_mul_f32_dpp v35, v19, v35 quad_perm:[1,1,3,3] row_mask:0xf bank_mask:0xf
    v_mul_f32_dpp v36, v19, v36 quad_perm:[0,0,2,2] row_mask:0xf bank_mask:0xf
    v_mul_f32_dpp v37, v19, v37 quad_perm:[1,1,3,3] row_mask:0xf bank_mask:0xf
    v_mul_f32_dpp v38, v19, v38 quad_perm:[0,0,2,2] row_mask:0xf bank_mask:0xf
    v_mul_f32_dpp v39, v19, v39 quad_perm:[1,1,3,3] row_mask:0xf bank_mask:0xf
    v_cndmask_b32 v40, 0, v24, s[64:65]
    v_cndmask_b32 v41, 0, v25, s[64:65]
    v_cndmask_b32 v42, 0, v24, s[66:67]
    v_cndmask_b32 v43, 0, v25, s[66:67]
    v_cndmask_b32 v44, 0, v24, s[68:69]
    v_cndmask_b32 v45, 0, v25, s[68:69]
    v_cndmask_b32 v46, 0, v24, s[70:71]
    v_cndmask_b32 v47, 0, v25, s[70:71]
    v_cndmask_b32 v48, 0, v24, s[72:73]
    v_cndmask_b32 v49, 0, v25, s[72:73]
    v_cndmask_b32 v50, 0, v24, s[74:75]
    v_cndmask_b32 v51, 0, v25, s[74:75]
    v_cndmask_b32 v52, 0, v24, s[76:77]
    v_cndmask_b32 v53, 0, v25, s[76:77]
    v_cndmask_b32 v54, 0, v24, s[78:79]
    v_cndmask_b32 v55, 0, v25, s[78:79]
    v_perm_b32 v56, v100, v96, s12
    v_perm_b32 v57, v108, v104, s12
    v_perm_b32 v58, v102, v98, s12
    v_perm_b32 v59, v110, v106, s12
    v_perm_b32 v60, v100, v96, s13
    v_perm_b32 v61, v108, v104, s13
    v_mfma_f32_16x16x16_bf16 v[32:35], v[40:41], v[56:57], v[32:35]
    v_perm_b32 v62, v102, v98, s13
    v_perm_b32 v63, v110, v106, s13
    v_mfma_f32_16x16x16_bf16 v[36:39], v[40:41], v[58:59], v[36:39]
    v_perm_b32 v56, v101, v97, s12
    v_perm_b32 v57, v109, v105, s12
    v_mfma_f32_16x16x16_bf16 v[32:35], v[44:45], v[60:61], v[32:35]
    v_perm_b32 v58, v103, v99, s12
    v_perm_b32 v59, v111, v107, s12
    v_mfma_f32_16x16x16_bf16 v[36:39], v[44:45], v[62:63], v[36:39]
    v_perm_b32 v60, v101, v97, s13
    v_perm_b32 v61, v109, v105, s13
    v_mfma_f32_16x16x16_bf16 v[32:35], v[48:49], v[56:57], v[32:35]
    v_perm_b32 v62, v103, v99, s13
    v_perm_b32 v63, v111, v107, s13
    v_mfma_f32_16x16x16_bf16 v[36:39], v[48:49], v[58:59], v[36:39]
    v_perm_b32 v56, v116, v112, s12
    v_perm_b32 v57, v124, v120, s12
    v_mfma_f32_16x16x16_bf16 v[32:35], v[52:53], v[60:61], v[32:35]
    v_perm_b32 v58, v118, v114, s12
    v_perm_b32 v59, v126, v122, s12
    v_mfma_f32_16x16x16_bf16 v[36:39], v[52:53], v[62:63], v[36:39]
    v_perm_b32 v60, v116, v112, s13
    v_perm_b32 v61, v124, v120, s13
    v_mfma_f32_16x16x16_bf16 v[32:35], v[42:43], v[56:57], v[32:35]
    v_perm_b32 v62, v118, v114, s13
    v_perm_b32 v63, v126, v122, s13
    v_mfma_f32_16x16x16_bf16 v[36:39], v[42:43], v[58:59], v[36:39]
    v_perm_b32 v56, v117, v113, s12
    v_perm_b32 v57, v125, v121, s12
    v_mfma_f32_16x16x16_bf16 v[32:35], v[46:47], v[60:61], v[32:35]
    v_perm_b32 v58, v119, v115, s12
    v_perm_b32 v59, v127, v123, s12
    v_mfma_f32_16x16x16_bf16 v[36:39], v[46:47], v[62:63], v[36:39]
    v_perm_b32 v60, v117, v113, s13
    v_perm_b32 v61, v125, v121, s13
    v_mfma_f32_16x16x16_bf16 v[32:35], v[50:51], v[56:57], v[32:35]
    v_perm_b32 v62, v119, v115, s13
    v_perm_b32 v63, v127, v123, s13
    v_mfma_f32_16x16x16_bf16 v[36:39], v[50:51], v[58:59], v[36:39]
    v_mfma_f32_16x16x16_bf16 v[32:35], v[54:55], v[60:61], v[32:35]
    v_mfma_f32_16x16x16_bf16 v[36:39], v[54:55], v[62:63], v[36:39]
    s_waitcnt vmcnt(7)
    buffer_load_dwordx4 v[96:99], v12, s[48:51], s10 offen offset:0 nt
    ds_read_b128 v[40:43], v13 offset:8192
    ds_read_b128 v[44:47], v14 offset:8192
    ds_read_b128 v[48:51], v15 offset:8192
    ds_read_b128 v[52:55], v16 offset:8192
    s_waitcnt lgkmcnt(3)
    v_mfma_f32_16x16x32_bf16 v[24:27], v[40:43], v[64:67], 0
    ds_read_b128 v[40:43], v13 offset:8448
    s_waitcnt lgkmcnt(3)
    v_mfma_f32_16x16x32_bf16 v[24:27], v[44:47], v[68:71], v[24:27]
    ds_read_b128 v[44:47], v14 offset:8448
    s_waitcnt lgkmcnt(3)
    v_mfma_f32_16x16x32_bf16 v[24:27], v[48:51], v[72:75], v[24:27]
    ds_read_b128 v[48:51], v15 offset:8448
    s_waitcnt lgkmcnt(3)
    v_mfma_f32_16x16x32_bf16 v[24:27], v[52:55], v[76:79], v[24:27]
    ds_read_b128 v[52:55], v16 offset:8448
    s_waitcnt lgkmcnt(3)
    v_mfma_f32_16x16x32_bf16 v[24:27], v[40:43], v[80:83], v[24:27]
    s_waitcnt lgkmcnt(2)
    v_mfma_f32_16x16x32_bf16 v[24:27], v[44:47], v[84:87], v[24:27]
    s_waitcnt lgkmcnt(1)
    v_mfma_f32_16x16x32_bf16 v[24:27], v[48:51], v[88:91], v[24:27]
    s_waitcnt lgkmcnt(0)
    v_mfma_f32_16x16x32_bf16 v[24:27], v[52:55], v[92:95], v[24:27]
    s_nop 7
    v_cvt_pk_bf16_f32 v28, 0, v24
    v_cvt_pk_bf16_f32 v29, 0, v25
    v_cvt_pk_bf16_f32 v30, 0, v26
    v_cvt_pk_bf16_f32 v31, 0, v27
    v_max3_f32 v21, v28, v29, v30
    v_max3_f32 v21, v21, v31, v17
    v_mov_b32 v22, v21
    s_nop 1
    v_permlane32_swap_b32 v21, v22
    v_max_f32 v21, v21, v22
    v_mov_b32 v22, v21
    s_nop 1
    v_permlane16_swap_b32 v21, v22
    v_max_f32 v21, v21, v22
    v_sub_f32 v19, v17, v21
    v_sub_f32 v28, v28, v21
    v_sub_f32 v29, v29, v21
    v_sub_f32 v30, v30, v21
    v_sub_f32 v31, v31, v21
    v_mul_f32 v19, s14, v19
    v_mul_f32 v28, s14, v28
    v_mul_f32 v29, s14, v29
    s_waitcnt vmcnt(7)
    buffer_load_dwordx4 v[100:103], v12, s[48:51], s10 offen offset:512 nt
    v_mul_f32 v30, s14, v30
    v_mul_f32 v31, s14, v31
    v_exp_f32 v19, v19
    v_exp_f32 v28, v28
    v_exp_f32 v29, v29
    v_exp_f32 v30, v30
    v_exp_f32 v31, v31
    v_mov_b32 v17, v21
    v_cvt_pk_bf16_f32 v24, v28, v29
    v_cvt_pk_bf16_f32 v25, v30, v31
    v_add_f32 v21, v28, v29
    v_add_f32 v22, v30, v31
    v_add_f32 v21, v21, v22
    v_fma_f32 v18, v18, v19, v21
    v_mul_f32_dpp v32, v19, v32 quad_perm:[0,0,2,2] row_mask:0xf bank_mask:0xf
    v_mul_f32_dpp v33, v19, v33 quad_perm:[1,1,3,3] row_mask:0xf bank_mask:0xf
    v_mul_f32_dpp v34, v19, v34 quad_perm:[0,0,2,2] row_mask:0xf bank_mask:0xf
    v_mul_f32_dpp v35, v19, v35 quad_perm:[1,1,3,3] row_mask:0xf bank_mask:0xf
    v_mul_f32_dpp v36, v19, v36 quad_perm:[0,0,2,2] row_mask:0xf bank_mask:0xf
    v_mul_f32_dpp v37, v19, v37 quad_perm:[1,1,3,3] row_mask:0xf bank_mask:0xf
    v_mul_f32_dpp v38, v19, v38 quad_perm:[0,0,2,2] row_mask:0xf bank_mask:0xf
    v_mul_f32_dpp v39, v19, v39 quad_perm:[1,1,3,3] row_mask:0xf bank_mask:0xf
    v_cndmask_b32 v40, 0, v24, s[64:65]
    v_cndmask_b32 v41, 0, v25, s[64:65]
    v_cndmask_b32 v42, 0, v24, s[66:67]
    v_cndmask_b32 v43, 0, v25, s[66:67]
    v_cndmask_b32 v44, 0, v24, s[68:69]
    v_cndmask_b32 v45, 0, v25, s[68:69]
    v_cndmask_b32 v46, 0, v24, s[70:71]
    v_cndmask_b32 v47, 0, v25, s[70:71]
    v_cndmask_b32 v48, 0, v24, s[72:73]
    v_cndmask_b32 v49, 0, v25, s[72:73]
    v_cndmask_b32 v50, 0, v24, s[74:75]
    v_cndmask_b32 v51, 0, v25, s[74:75]
    v_cndmask_b32 v52, 0, v24, s[76:77]
    v_cndmask_b32 v53, 0, v25, s[76:77]
    v_cndmask_b32 v54, 0, v24, s[78:79]
    v_cndmask_b32 v55, 0, v25, s[78:79]
    v_perm_b32 v56, v132, v128, s12
    v_perm_b32 v57, v140, v136, s12
    v_perm_b32 v58, v134, v130, s12
    v_perm_b32 v59, v142, v138, s12
    v_perm_b32 v60, v132, v128, s13
    v_perm_b32 v61, v140, v136, s13
    s_waitcnt vmcnt(7)
    buffer_load_dwordx4 v[104:107], v12, s[48:51], s10 offen offset:1024 nt
    v_mfma_f32_16x16x16_bf16 v[32:35], v[40:41], v[56:57], v[32:35]
    v_perm_b32 v62, v134, v130, s13
    v_perm_b32 v63, v142, v138, s13
    v_mfma_f32_16x16x16_bf16 v[36:39], v[40:41], v[58:59], v[36:39]
    v_perm_b32 v56, v133, v129, s12
    v_perm_b32 v57, v141, v137, s12
    v_mfma_f32_16x16x16_bf16 v[32:35], v[44:45], v[60:61], v[32:35]
    v_perm_b32 v58, v135, v131, s12
    v_perm_b32 v59, v143, v139, s12
    v_mfma_f32_16x16x16_bf16 v[36:39], v[44:45], v[62:63], v[36:39]
    v_perm_b32 v60, v133, v129, s13
    v_perm_b32 v61, v141, v137, s13
    v_mfma_f32_16x16x16_bf16 v[32:35], v[48:49], v[56:57], v[32:35]
    v_perm_b32 v62, v135, v131, s13
    v_perm_b32 v63, v143, v139, s13
    v_mfma_f32_16x16x16_bf16 v[36:39], v[48:49], v[58:59], v[36:39]
    v_perm_b32 v56, v148, v144, s12
    v_perm_b32 v57, v156, v152, s12
    v_mfma_f32_16x16x16_bf16 v[32:35], v[52:53], v[60:61], v[32:35]
    v_perm_b32 v58, v150, v146, s12
    v_perm_b32 v59, v158, v154, s12
    v_mfma_f32_16x16x16_bf16 v[36:39], v[52:53], v[62:63], v[36:39]
    v_perm_b32 v60, v148, v144, s13
    v_perm_b32 v61, v156, v152, s13
    v_mfma_f32_16x16x16_bf16 v[32:35], v[42:43], v[56:57], v[32:35]
    v_perm_b32 v62, v150, v146, s13
    v_perm_b32 v63, v158, v154, s13
    v_mfma_f32_16x16x16_bf16 v[36:39], v[42:43], v[58:59], v[36:39]
    v_perm_b32 v56, v149, v145, s12
    v_perm_b32 v57, v157, v153, s12
    v_mfma_f32_16x16x16_bf16 v[32:35], v[46:47], v[60:61], v[32:35]
    v_perm_b32 v58, v151, v147, s12
    v_perm_b32 v59, v159, v155, s12
    v_mfma_f32_16x16x16_bf16 v[36:39], v[46:47], v[62:63], v[36:39]
    v_perm_b32 v60, v149, v145, s13
    v_perm_b32 v61, v157, v153, s13
    v_mfma_f32_16x16x16_bf16 v[32:35], v[50:51], v[56:57], v[32:35]
    v_perm_b32 v62, v151, v147, s13
    v_perm_b32 v63, v159, v155, s13
    v_mfma_f32_16x16x16_bf16 v[36:39], v[50:51], v[58:59], v[36:39]
    v_mfma_f32_16x16x16_bf16 v[32:35], v[54:55], v[60:61], v[32:35]
    v_mfma_f32_16x16x16_bf16 v[36:39], v[54:55], v[62:63], v[36:39]
    v_lshl_add_u32 v21, v0, 4, s101
    ds_write_b128 v21, v[224:227] offset:0
    s_waitcnt vmcnt(7)
    buffer_load_dwordx4 v[108:111], v12, s[48:51], s10 offen offset:1536 nt
    ds_write_b128 v21, v[228:231] offset:1024
    ds_write_b128 v21, v[232:235] offset:2048
    ds_write_b128 v21, v[236:239] offset:3072
    ds_write_b128 v21, v[240:243] offset:4096
    ds_write_b128 v21, v[244:247] offset:5120
    ds_write_b128 v21, v[248:251] offset:6144
    ds_write_b128 v21, v[252:255] offset:7168
    s_waitcnt lgkmcnt(0)
    ds_read_b128 v[40:43], v13 offset:16384
    ds_read_b128 v[44:47], v14 offset:16384
    ds_read_b128 v[48:51], v15 offset:16384
    ds_read_b128 v[52:55], v16 offset:16384
    s_waitcnt lgkmcnt(3)
    v_mfma_f32_16x16x32_bf16 v[24:27], v[40:43], v[64:67], 0
    ds_read_b128 v[40:43], v13 offset:16640
    s_waitcnt lgkmcnt(3)
    v_mfma_f32_16x16x32_bf16 v[24:27], v[44:47], v[68:71], v[24:27]
    ds_read_b128 v[44:47], v14 offset:16640
    s_waitcnt lgkmcnt(3)
    v_mfma_f32_16x16x32_bf16 v[24:27], v[48:51], v[72:75], v[24:27]
    ds_read_b128 v[48:51], v15 offset:16640
    s_waitcnt lgkmcnt(3)
    v_mfma_f32_16x16x32_bf16 v[24:27], v[52:55], v[76:79], v[24:27]
    ds_read_b128 v[52:55], v16 offset:16640
    s_waitcnt lgkmcnt(3)
    v_mfma_f32_16x16x32_bf16 v[24:27], v[40:43], v[80:83], v[24:27]
    s_waitcnt lgkmcnt(2)
    v_mfma_f32_16x16x32_bf16 v[24:27], v[44:47], v[84:87], v[24:27]
    s_waitcnt lgkmcnt(1)
    v_mfma_f32_16x16x32_bf16 v[24:27], v[48:51], v[88:91], v[24:27]
    s_waitcnt lgkmcnt(0)
    v_mfma_f32_16x16x32_bf16 v[24:27], v[52:55], v[92:95], v[24:27]
    s_nop 7
    v_cvt_pk_bf16_f32 v28, 0, v24
    v_cvt_pk_bf16_f32 v29, 0, v25
    v_cvt_pk_bf16_f32 v30, 0, v26
    v_cvt_pk_bf16_f32 v31, 0, v27
    v_max3_f32 v21, v28, v29, v30
    v_max3_f32 v21, v21, v31, v17
    v_mov_b32 v22, v21
    s_nop 1
    v_permlane32_swap_b32 v21, v22
    v_max_f32 v21, v21, v22
    v_mov_b32 v22, v21
    s_nop 1
    v_permlane16_swap_b32 v21, v22
    v_max_f32 v21, v21, v22
    s_waitcnt vmcnt(7)
    buffer_load_dwordx4 v[112:115], v12, s[48:51], s10 offen offset:256 nt
    v_sub_f32 v19, v17, v21
    v_sub_f32 v28, v28, v21
    v_sub_f32 v29, v29, v21
    v_sub_f32 v30, v30, v21
    v_sub_f32 v31, v31, v21
    v_mul_f32 v19, s14, v19
    v_mul_f32 v28, s14, v28
    v_mul_f32 v29, s14, v29
    v_mul_f32 v30, s14, v30
    v_mul_f32 v31, s14, v31
    v_exp_f32 v19, v19
    v_exp_f32 v28, v28
    v_exp_f32 v29, v29
    v_exp_f32 v30, v30
    v_exp_f32 v31, v31
    v_mov_b32 v17, v21
    v_cvt_pk_bf16_f32 v24, v28, v29
    v_cvt_pk_bf16_f32 v25, v30, v31
    v_add_f32 v21, v28, v29
    v_add_f32 v22, v30, v31
    v_add_f32 v21, v21, v22
    v_fma_f32 v18, v18, v19, v21
    v_mul_f32_dpp v32, v19, v32 quad_perm:[0,0,2,2] row_mask:0xf bank_mask:0xf
    v_mul_f32_dpp v33, v19, v33 quad_perm:[1,1,3,3] row_mask:0xf bank_mask:0xf
    v_mul_f32_dpp v34, v19, v34 quad_perm:[0,0,2,2] row_mask:0xf bank_mask:0xf
    v_mul_f32_dpp v35, v19, v35 quad_perm:[1,1,3,3] row_mask:0xf bank_mask:0xf
    v_mul_f32_dpp v36, v19, v36 quad_perm:[0,0,2,2] row_mask:0xf bank_mask:0xf
    v_mul_f32_dpp v37, v19, v37 quad_perm:[1,1,3,3] row_mask:0xf bank_mask:0xf
    v_mul_f32_dpp v38, v19, v38 quad_perm:[0,0,2,2] row_mask:0xf bank_mask:0xf
    v_mul_f32_dpp v39, v19, v39 quad_perm:[1,1,3,3] row_mask:0xf bank_mask:0xf
    v_cndmask_b32 v40, 0, v24, s[64:65]
    v_cndmask_b32 v41, 0, v25, s[64:65]
    v_cndmask_b32 v42, 0, v24, s[66:67]
    v_cndmask_b32 v43, 0, v25, s[66:67]
    v_cndmask_b32 v44, 0, v24, s[68:69]
    v_cndmask_b32 v45, 0, v25, s[68:69]
    v_cndmask_b32 v46, 0, v24, s[70:71]
    v_cndmask_b32 v47, 0, v25, s[70:71]
    v_cndmask_b32 v48, 0, v24, s[72:73]
    v_cndmask_b32 v49, 0, v25, s[72:73]
    v_cndmask_b32 v50, 0, v24, s[74:75]
    v_cndmask_b32 v51, 0, v25, s[74:75]
    v_cndmask_b32 v52, 0, v24, s[76:77]
    v_cndmask_b32 v53, 0, v25, s[76:77]
    s_waitcnt vmcnt(7)
    buffer_load_dwordx4 v[116:119], v12, s[48:51], s10 offen offset:768 nt
    v_cndmask_b32 v54, 0, v24, s[78:79]
    v_cndmask_b32 v55, 0, v25, s[78:79]
    v_perm_b32 v56, v164, v160, s12
    v_perm_b32 v57, v172, v168, s12
    v_perm_b32 v58, v166, v162, s12
    v_perm_b32 v59, v174, v170, s12
    v_perm_b32 v60, v164, v160, s13
    v_perm_b32 v61, v172, v168, s13
    v_mfma_f32_16x16x16_bf16 v[32:35], v[40:41], v[56:57], v[32:35]
    v_perm_b32 v62, v166, v162, s13
    v_perm_b32 v63, v174, v170, s13
    v_mfma_f32_16x16x16_bf16 v[36:39], v[40:41], v[58:59], v[36:39]
    v_perm_b32 v56, v165, v161, s12
    v_perm_b32 v57, v173, v169, s12
    v_mfma_f32_16x16x16_bf16 v[32:35], v[44:45], v[60:61], v[32:35]
    v_perm_b32 v58, v167, v163, s12
    v_perm_b32 v59, v175, v171, s12
    v_mfma_f32_16x16x16_bf16 v[36:39], v[44:45], v[62:63], v[36:39]
    v_perm_b32 v60, v165, v161, s13
    v_perm_b32 v61, v173, v169, s13
    v_mfma_f32_16x16x16_bf16 v[32:35], v[48:49], v[56:57], v[32:35]
    v_perm_b32 v62, v167, v163, s13
    v_perm_b32 v63, v175, v171, s13
    v_mfma_f32_16x16x16_bf16 v[36:39], v[48:49], v[58:59], v[36:39]
    v_perm_b32 v56, v180, v176, s12
    v_perm_b32 v57, v188, v184, s12
    v_mfma_f32_16x16x16_bf16 v[32:35], v[52:53], v[60:61], v[32:35]
    v_perm_b32 v58, v182, v178, s12
    v_perm_b32 v59, v190, v186, s12
    v_mfma_f32_16x16x16_bf16 v[36:39], v[52:53], v[62:63], v[36:39]
    v_perm_b32 v60, v180, v176, s13
    v_perm_b32 v61, v188, v184, s13
    v_mfma_f32_16x16x16_bf16 v[32:35], v[42:43], v[56:57], v[32:35]
    v_perm_b32 v62, v182, v178, s13
    v_perm_b32 v63, v190, v186, s13
    v_mfma_f32_16x16x16_bf16 v[36:39], v[42:43], v[58:59], v[36:39]
    v_perm_b32 v56, v181, v177, s12
    v_perm_b32 v57, v189, v185, s12
    v_mfma_f32_16x16x16_bf16 v[32:35], v[46:47], v[60:61], v[32:35]
    v_perm_b32 v58, v183, v179, s12
    v_perm_b32 v59, v191, v187, s12
    v_mfma_f32_16x16x16_bf16 v[36:39], v[46:47], v[62:63], v[36:39]
    v_perm_b32 v60, v181, v177, s13
    v_perm_b32 v61, v189, v185, s13
    s_waitcnt vmcnt(7)
    buffer_load_dwordx4 v[120:123], v12, s[48:51], s10 offen offset:1280 nt
    v_mfma_f32_16x16x16_bf16 v[32:35], v[50:51], v[56:57], v[32:35]
    v_perm_b32 v62, v183, v179, s13
    v_perm_b32 v63, v191, v187, s13
    v_mfma_f32_16x16x16_bf16 v[36:39], v[50:51], v[58:59], v[36:39]
    v_mfma_f32_16x16x16_bf16 v[32:35], v[54:55], v[60:61], v[32:35]
    v_mfma_f32_16x16x16_bf16 v[36:39], v[54:55], v[62:63], v[36:39]
    ds_read_b128 v[40:43], v13 offset:24576
    ds_read_b128 v[44:47], v14 offset:24576
    ds_read_b128 v[48:51], v15 offset:24576
    ds_read_b128 v[52:55], v16 offset:24576
    s_waitcnt lgkmcnt(3)
    v_mfma_f32_16x16x32_bf16 v[24:27], v[40:43], v[64:67], 0
    ds_read_b128 v[40:43], v13 offset:24832
    s_waitcnt lgkmcnt(3)
    v_mfma_f32_16x16x32_bf16 v[24:27], v[44:47], v[68:71], v[24:27]
    ds_read_b128 v[44:47], v14 offset:24832
    s_waitcnt lgkmcnt(3)
    v_mfma_f32_16x16x32_bf16 v[24:27], v[48:51], v[72:75], v[24:27]
    ds_read_b128 v[48:51], v15 offset:24832
    s_waitcnt lgkmcnt(3)
    v_mfma_f32_16x16x32_bf16 v[24:27], v[52:55], v[76:79], v[24:27]
    ds_read_b128 v[52:55], v16 offset:24832
    s_waitcnt lgkmcnt(3)
    v_mfma_f32_16x16x32_bf16 v[24:27], v[40:43], v[80:83], v[24:27]
    s_waitcnt lgkmcnt(2)
    v_mfma_f32_16x16x32_bf16 v[24:27], v[44:47], v[84:87], v[24:27]
    s_waitcnt lgkmcnt(1)
    v_mfma_f32_16x16x32_bf16 v[24:27], v[48:51], v[88:91], v[24:27]
    s_waitcnt lgkmcnt(0)
    v_mfma_f32_16x16x32_bf16 v[24:27], v[52:55], v[92:95], v[24:27]
    s_nop 7
    v_cvt_pk_bf16_f32 v28, 0, v24
    v_cvt_pk_bf16_f32 v29, 0, v25
    v_cvt_pk_bf16_f32 v30, 0, v26
    v_cvt_pk_bf16_f32 v31, 0, v27
    v_max3_f32 v21, v28, v29, v30
    v_max3_f32 v21, v21, v31, v17
    v_mov_b32 v22, v21
    s_nop 1
    v_permlane32_swap_b32 v21, v22
    v_max_f32 v21, v21, v22
    v_mov_b32 v22, v21
    s_nop 1
    v_permlane16_swap_b32 v21, v22
    v_max_f32 v21, v21, v22
    v_sub_f32 v19, v17, v21
    v_sub_f32 v28, v28, v21
    s_waitcnt vmcnt(7)
    buffer_load_dwordx4 v[124:127], v12, s[48:51], s10 offen offset:1792 nt
    v_sub_f32 v29, v29, v21
    v_sub_f32 v30, v30, v21
    v_sub_f32 v31, v31, v21
    v_mul_f32 v19, s14, v19
    v_mul_f32 v28, s14, v28
    v_mul_f32 v29, s14, v29
    v_mul_f32 v30, s14, v30
    v_mul_f32 v31, s14, v31
    v_exp_f32 v19, v19
    v_exp_f32 v28, v28
    v_exp_f32 v29, v29
    v_exp_f32 v30, v30
    v_exp_f32 v31, v31
    v_mov_b32 v17, v21
    v_cvt_pk_bf16_f32 v24, v28, v29
    v_cvt_pk_bf16_f32 v25, v30, v31
    v_add_f32 v21, v28, v29
    v_add_f32 v22, v30, v31
    v_add_f32 v21, v21, v22
    v_fma_f32 v18, v18, v19, v21
    v_mul_f32_dpp v32, v19, v32 quad_perm:[0,0,2,2] row_mask:0xf bank_mask:0xf
    v_mul_f32_dpp v33, v19, v33 quad_perm:[1,1,3,3] row_mask:0xf bank_mask:0xf
    v_mul_f32_dpp v34, v19, v34 quad_perm:[0,0,2,2] row_mask:0xf bank_mask:0xf
    v_mul_f32_dpp v35, v19, v35 quad_perm:[1,1,3,3] row_mask:0xf bank_mask:0xf
    v_mul_f32_dpp v36, v19, v36 quad_perm:[0,0,2,2] row_mask:0xf bank_mask:0xf
    v_mul_f32_dpp v37, v19, v37 quad_perm:[1,1,3,3] row_mask:0xf bank_mask:0xf
    v_mul_f32_dpp v38, v19, v38 quad_perm:[0,0,2,2] row_mask:0xf bank_mask:0xf
    v_mul_f32_dpp v39, v19, v39 quad_perm:[1,1,3,3] row_mask:0xf bank_mask:0xf
    v_cndmask_b32 v40, 0, v24, s[64:65]
    v_cndmask_b32 v41, 0, v25, s[64:65]
    v_cndmask_b32 v42, 0, v24, s[66:67]
    v_cndmask_b32 v43, 0, v25, s[66:67]
    v_cndmask_b32 v44, 0, v24, s[68:69]
    v_cndmask_b32 v45, 0, v25, s[68:69]
    v_cndmask_b32 v46, 0, v24, s[70:71]
    v_cndmask_b32 v47, 0, v25, s[70:71]
    v_cndmask_b32 v48, 0, v24, s[72:73]
    v_cndmask_b32 v49, 0, v25, s[72:73]
    v_cndmask_b32 v50, 0, v24, s[74:75]
    v_cndmask_b32 v51, 0, v25, s[74:75]
    v_cndmask_b32 v52, 0, v24, s[76:77]
    v_cndmask_b32 v53, 0, v25, s[76:77]
    v_cndmask_b32 v54, 0, v24, s[78:79]
    v_cndmask_b32 v55, 0, v25, s[78:79]
    s_mov_b32 s58, s99
    s_add_u32 s99, s99, 28
    s_cmp_lt_i32 s58, s97
    s_cbranch_scc1 L_tk2
    s_mov_b32 s58, 1
    s_atomic_add s58, s[56:57], 0 glc
L_tk2:
    s_waitcnt vmcnt(8)
    v_perm_b32 v56, v196, v192, s12
    v_perm_b32 v57, v204, v200, s12
    v_perm_b32 v58, v198, v194, s12
    v_perm_b32 v59, v206, v202, s12
    v_perm_b32 v60, v196, v192, s13
    v_perm_b32 v61, v204, v200, s13
    v_mfma_f32_16x16x16_bf16 v[32:35], v[40:41], v[56:57], v[32:35]
    v_perm_b32 v62, v198, v194, s13
    v_perm_b32 v63, v206, v202, s13
    v_mfma_f32_16x16x16_bf16 v[36:39], v[40:41], v[58:59], v[36:39]
    v_perm_b32 v56, v197, v193, s12
    v_perm_b32 v57, v205, v201, s12
    v_mfma_f32_16x16x16_bf16 v[32:35], v[44:45], v[60:61], v[32:35]
    v_perm_b32 v58, v199, v195, s12
    v_perm_b32 v59, v207, v203, s12
    v_mfma_f32_16x16x16_bf16 v[36:39], v[44:45], v[62:63], v[36:39]
    v_perm_b32 v60, v197, v193, s13
    v_perm_b32 v61, v205, v201, s13
    v_mfma_f32_16x16x16_bf16 v[32:35], v[48:49], v[56:57], v[32:35]
    v_perm_b32 v62, v199, v195, s13
    v_perm_b32 v63, v207, v203, s13
    v_mfma_f32_16x16x16_bf16 v[36:39], v[48:49], v[58:59], v[36:39]
    v_perm_b32 v56, v212, v208, s12
    v_perm_b32 v57, v220, v216, s12
    v_mfma_f32_16x16x16_bf16 v[32:35], v[52:53], v[60:61], v[32:35]
    v_perm_b32 v58, v214, v210, s12
    v_perm_b32 v59, v222, v218, s12
    v_mfma_f32_16x16x16_bf16 v[36:39], v[52:53], v[62:63], v[36:39]
    v_perm_b32 v60, v212, v208, s13
    v_perm_b32 v61, v220, v216, s13
    v_mfma_f32_16x16x16_bf16 v[32:35], v[42:43], v[56:57], v[32:35]
    v_perm_b32 v62, v214, v210, s13
    v_perm_b32 v63, v222, v218, s13
    v_mfma_f32_16x16x16_bf16 v[36:39], v[42:43], v[58:59], v[36:39]
    v_perm_b32 v56, v213, v209, s12
    v_perm_b32 v57, v221, v217, s12
    v_mfma_f32_16x16x16_bf16 v[32:35], v[46:47], v[60:61], v[32:35]
    v_perm_b32 v58, v215, v211, s12
    v_perm_b32 v59, v223, v219, s12
    v_mfma_f32_16x16x16_bf16 v[36:39], v[46:47], v[62:63], v[36:39]
    v_perm_b32 v60, v213, v209, s13
    v_perm_b32 v61, v221, v217, s13
    v_mfma_f32_16x16x16_bf16 v[32:35], v[50:51], v[56:57], v[32:35]
    v_perm_b32 v62, v215, v211, s13
    v_perm_b32 v63, v223, v219, s13
    v_mfma_f32_16x16x16_bf16 v[36:39], v[50:51], v[58:59], v[36:39]
    v_mfma_f32_16x16x16_bf16 v[32:35], v[54:55], v[60:61], v[32:35]
    v_mfma_f32_16x16x16_bf16 v[36:39], v[54:55], v[62:63], v[36:39]
    s_add_u32 s11, s11, 1720320
    s_nop 5
    s_branch L_body0
L_body0:
    s_waitcnt lgkmcnt(0)
    s_cmp_ge_i32 s58, 46
    s_cbranch_scc1 L_drain0
    s_lshl_b32 s10, s58, 13
    s_add_u32 s10, s10, s11
    s_waitcnt vmcnt(8)
    s_add_u32 m0, s101, 8192
    s_waitcnt vmcnt(7)
    buffer_load_dwordx4 v4, s[44:47], s10 offen offset:0 nt lds
    ds_read_b128 v[40:43], v13 offset:0
    ds_read_b128 v[44:47], v14 offset:0
    ds_read_b128 v[48:51], v15 offset:0
    ds_read_b128 v[52:55], v16 offset:0
    s_waitcnt lgkmcnt(3)
    v_mfma_f32_16x16x32_bf16 v[24:27], v[40:43], v[64:67], 0
    ds_read_b128 v[40:43], v13 offset:256
    s_waitcnt lgkmcnt(3)
    v_mfma_f32_16x16x32_bf16 v[24:27], v[44:47], v[68:71], v[24:27]
    ds_read_b128 v[44:47], v14 offset:256
    s_add_u32 m0, s101, 12288
    s_waitcnt vmcnt(7)
    buffer_load_dwordx4 v8, s[44:47], s10 offen offset:0 nt lds
    s_waitcnt lgkmcnt(3)
    v_mfma_f32_16x16x32_bf16 v[24:27], v[48:51], v[72:75], v[24:27]
    ds_read_b128 v[48:51], v15 offset:256
    s_waitcnt lgkmcnt(3)
    v_mfma_f32_16x16x32_bf16 v[24:27], v[52:55], v[76:79], v[24:27]
    ds_read_b128 v[52:55], v16 offset:256
    s_waitcnt lgkmcnt(3)
    v_mfma_f32_16x16x32_bf16 v[24:27], v[40:43], v[80:83], v[24:27]
    s_waitcnt lgkmcnt(2)
    v_mfma_f32_16x16x32_bf16 v[24:27], v[44:47], v[84:87], v[24:27]
    s_add_u32 m0, s101, 8192
    s_waitcnt vmcnt(7)
    buffer_load_dwordx4 v5, s[44:47], s10 offen offset:1024 nt lds
    s_waitcnt lgkmcnt(1)
    v_mfma_f32_16x16x32_bf16 v[24:27], v[48:51], v[88:91], v[24:27]
    s_waitcnt lgkmcnt(0)
    v_mfma_f32_16x16x32_bf16 v[24:27], v[52:55], v[92:95], v[24:27]
    s_nop 7
    v_cvt_pk_bf16_f32 v28, 0, v24
    v_cvt_pk_bf16_f32 v29, 0, v25
    v_cvt_pk_bf16_f32 v30, 0, v26
    v_cvt_pk_bf16_f32 v31, 0, v27
    v_max3_f32 v21, v28, v29, v30
    v_max3_f32 v21, v21, v31, v17
    s_add_u32 m0, s101, 12288
    s_waitcnt vmcnt(7)
    buffer_load_dwordx4 v9, s[44:47], s10 offen offset:1024 nt lds
    v_mov_b32 v22, v21
    s_nop 1
    v_permlane32_swap_b32 v21, v22
    v_max_f32 v21, v21, v22
    v_mov_b32 v22, v21
    s_nop 1
    v_permlane16_swap_b32 v21, v22
    v_max_f32 v21, v21, v22
    v_sub_f32 v19, v17, v21
    v_sub_f32 v28, v28, v21
    v_sub_f32 v29, v29, v21
    v_sub_f32 v30, v30, v21
    v_sub_f32 v31, v31, v21
    s_add_u32 m0, s101, 8192
    s_waitcnt vmcnt(7)
    buffer_load_dwordx4 v6, s[44:47], s10 offen offset:2048 nt lds
    v_mul_f32 v19, s14, v19
    v_mul_f32 v28, s14, v28
    v_mul_f32 v29, s14, v29
    v_mul_f32 v30, s14, v30
    v_mul_f32 v31, s14, v31
    v_exp_f32 v19, v19
    v_exp_f32 v28, v28
    v_exp_f32 v29, v29
    v_exp_f32 v30, v30
    v_exp_f32 v31, v31
    s_add_u32 m0, s101, 12288
    s_waitcnt vmcnt(7)
    buffer_load_dwordx4 v10, s[44:47], s10 offen offset:2048 nt lds
    v_mov_b32 v17, v21
    v_cvt_pk_bf16_f32 v24, v28, v29
    v_cvt_pk_bf16_f32 v25, v30, v31
    v_add_f32 v21, v28, v29
    v_add_f32 v22, v30, v31
    v_add_f32 v21, v21, v22
    v_fma_f32 v18, v18, v19, v21
    v_mul_f32_dpp v32, v19, v32 quad_perm:[0,0,2,2] row_mask:0xf bank_mask:0xf
    v_mul_f32_dpp v33, v19, v33 quad_perm:[1,1,3,3] row_mask:0xf bank_mask:0xf
    v_mul_f32_dpp v34, v19, v34 quad_perm:[0,0,2,2] row_mask:0xf bank_mask:0xf
    s_add_u32 m0, s101, 8192
    s_waitcnt vmcnt(7)
    buffer_load_dwordx4 v7, s[44:47], s10 offen offset:3072 nt lds
    v_mul_f32_dpp v35, v19, v35 quad_perm:[1,1,3,3] row_mask:0xf bank_mask:0xf
    v_mul_f32_dpp v36, v19, v36 quad_perm:[0,0,2,2] row_mask:0xf bank_mask:0xf
    v_mul_f32_dpp v37, v19, v37 quad_perm:[1,1,3,3] row_mask:0xf bank_mask:0xf
    v_mul_f32_dpp v38, v19, v38 quad_perm:[0,0,2,2] row_mask:0xf bank_mask:0xf
    v_mul_f32_dpp v39, v19, v39 quad_perm:[1,1,3,3] row_mask:0xf bank_mask:0xf
    v_cndmask_b32 v40, 0, v24, s[64:65]
    v_cndmask_b32 v41, 0, v25, s[64:65]
    v_cndmask_b32 v42, 0, v24, s[66:67]
    v_cndmask_b32 v43, 0, v25, s[66:67]
    v_cndmask_b32 v44, 0, v24, s[68:69]
    s_add_u32 m0, s101, 12288
    s_waitcnt vmcnt(7)
    buffer_load_dwordx4 v11, s[44:47], s10 offen offset:3072 nt lds
    v_cndmask_b32 v45, 0, v25, s[68:69]
    v_cndmask_b32 v46, 0, v24, s[70:71]
    v_cndmask_b32 v47, 0, v25, s[70:71]
    v_cndmask_b32 v48, 0, v24, s[72:73]
    v_cndmask_b32 v49, 0, v25, s[72:73]
    v_cndmask_b32 v50, 0, v24, s[74:75]
    v_cndmask_b32 v51, 0, v25, s[74:75]
    v_cndmask_b32 v52, 0, v24, s[76:77]
    v_cndmask_b32 v53, 0, v25, s[76:77]
    v_cndmask_b32 v54, 0, v24, s[78:79]
    v_cndmask_b32 v55, 0, v25, s[78:79]
    s_waitcnt vmcnt(8)
    s_waitcnt vmcnt(7)
    buffer_load_dwordx4 v[128:131], v12, s[48:51], s10 offen offset:0 nt
    v_perm_b32 v56, v100, v96, s12
    v_perm_b32 v57, v108, v104, s12
    v_perm_b32 v58, v102, v98, s12
    v_perm_b32 v59, v110, v106, s12
    v_perm_b32 v60, v100, v96, s13
    v_perm_b32 v61, v108, v104, s13
    s_waitcnt vmcnt(7)
    buffer_load_dwordx4 v[132:135], v12, s[48:51], s10 offen offset:512 nt
    v_mfma_f32_16x16x16_bf16 v[32:35], v[40:41], v[56:57], v[32:35]
    v_perm_b32 v62, v102, v98, s13
    v_perm_b32 v63, v110, v106, s13
    v_mfma_f32_16x16x16_bf16 v[36:39], v[40:41], v[58:59], v[36:39]
    v_perm_b32 v56, v101, v97, s12
    v_perm_b32 v57, v109, v105, s12
    s_waitcnt vmcnt(7)
    buffer_load_dwordx4 v[136:139], v12, s[48:51], s10 offen offset:1024 nt
    v_mfma_f32_16x16x16_bf16 v[32:35], v[44:45], v[60:61], v[32:35]
    v_perm_b32 v58, v103, v99, s12
    v_perm_b32 v59, v111, v107, s12
    v_mfma_f32_16x16x16_bf16 v[36:39], v[44:45], v[62:63], v[36:39]
    v_perm_b32 v60, v101, v97, s13
    v_perm_b32 v61, v109, v105, s13
    s_waitcnt vmcnt(7)
    buffer_load_dwordx4 v[140:143], v12, s[48:51], s10 offen offset:1536 nt
    v_mfma_f32_16x16x16_bf16 v[32:35], v[48:49], v[56:57], v[32:35]
    v_perm_b32 v62, v103, v99, s13
    v_perm_b32 v63, v111, v107, s13
    v_mfma_f32_16x16x16_bf16 v[36:39], v[48:49], v[58:59], v[36:39]
    v_perm_b32 v56, v116, v112, s12
    v_perm_b32 v57, v124, v120, s12
    s_waitcnt vmcnt(7)
    buffer_load_dwordx4 v[144:147], v12, s[48:51], s10 offen offset:256 nt
    v_mfma_f32_16x16x16_bf16 v[32:35], v[52:53], v[60:61], v[32:35]
    v_perm_b32 v58, v118, v114, s12
    v_perm_b32 v59, v126, v122, s12
    v_mfma_f32_16x16x16_bf16 v[36:39], v[52:53], v[62:63], v[36:39]
    v_perm_b32 v60, v116, v112, s13
    v_perm_b32 v61, v124, v120, s13
    s_mov_b32 s58, s99
    s_add_u32 s99, s99, 28
    s_cmp_lt_i32 s58, s97
    s_nop 1
    s_cbranch_scc1 L_tk3
    s_mov_b32 s58, 1
    s_atomic_add s58, s[56:57], 0 glc
L_tk3:
    s_waitcnt vmcnt(7)
    buffer_load_dwordx4 v[148:151], v12, s[48:51], s10 offen offset:768 nt
    v_mfma_f32_16x16x16_bf16 v[32:35], v[42:43], v[56:57], v[32:35]
    v_perm_b32 v62, v118, v114, s13
    v_perm_b32 v63, v126, v122, s13
    v_mfma_f32_16x16x16_bf16 v[36:39], v[42:43], v[58:59], v[36:39]
    v_perm_b32 v56, v117, v113, s12
    v_perm_b32 v57, v125, v121, s12
    s_waitcnt vmcnt(7)
    buffer_load_dwordx4 v[152:155], v12, s[48:51], s10 offen offset:1280 nt
    v_mfma_f32_16x16x16_bf16 v[32:35], v[46:47], v[60:61], v[32:35]
    v_perm_b32 v58, v119, v115, s12
    v_perm_b32 v59, v127, v123, s12
    v_mfma_f32_16x16x16_bf16 v[36:39], v[46:47], v[62:63], v[36:39]
    v_perm_b32 v60, v117, v113, s13
    v_perm_b32 v61, v125, v121, s13
    s_waitcnt vmcnt(7)
    buffer_load_dwordx4 v[156:159], v12, s[48:51], s10 offen offset:1792 nt
    v_mfma_f32_16x16x16_bf16 v[32:35], v[50:51], v[56:57], v[32:35]
    v_perm_b32 v62, v119, v115, s13
    v_perm_b32 v63, v127, v123, s13
    v_mfma_f32_16x16x16_bf16 v[36:39], v[50:51], v[58:59], v[36:39]
    v_mfma_f32_16x16x16_bf16 v[32:35], v[54:55], v[60:61], v[32:35]
    v_mfma_f32_16x16x16_bf16 v[36:39], v[54:55], v[62:63], v[36:39]
    s_nop 7
L_body1:
    s_waitcnt lgkmcnt(0)
    s_cmp_ge_i32 s58, 46
    s_cbranch_scc1 L_drain1
    s_lshl_b32 s10, s58, 13
    s_add_u32 s10, s10, s11
    s_waitcnt vmcnt(8)
    s_add_u32 m0, s101, 0
    s_waitcnt vmcnt(7)
    buffer_load_dwordx4 v4, s[44:47], s10 offen offset:0 nt lds
    ds_read_b128 v[40:43], v13 offset:8192
    ds_read_b128 v[44:47], v14 offset:8192
    ds_read_b128 v[48:51], v15 offset:8192
    ds_read_b128 v[52:55], v16 offset:8192
    s_waitcnt lgkmcnt(3)
    v_mfma_f32_16x16x32_bf16 v[24:27], v[40:43], v[64:67], 0
    ds_read_b128 v[40:43], v13 offset:8448
    s_waitcnt lgkmcnt(3)
    v_mfma_f32_16x16x32_bf16 v[24:27], v[44:47], v[68:71], v[24:27]
    ds_read_b128 v[44:47], v14 offset:8448
    s_add_u32 m0, s101, 4096
    s_waitcnt vmcnt(7)
    buffer_load_dwordx4 v8, s[44:47], s10 offen offset:0 nt lds
    s_waitcnt lgkmcnt(3)
    v_mfma_f32_16x16x32_bf16 v[24:27], v[48:51], v[72:75], v[24:27]
    ds_read_b128 v[48:51], v15 offset:8448
    s_waitcnt lgkmcnt(3)
    v_mfma_f32_16x16x32_bf16 v[24:27], v[52:55], v[76:79], v[24:27]
    ds_read_b128 v[52:55], v16 offset:8448
    s_waitcnt lgkmcnt(3)
    v_mfma_f32_16x16x32_bf16 v[24:27], v[40:43], v[80:83], v[24:27]
    s_waitcnt lgkmcnt(2)
    v_mfma_f32_16x16x32_bf16 v[24:27], v[44:47], v[84:87], v[24:27]
    s_add_u32 m0, s101, 0
    s_waitcnt vmcnt(7)
    buffer_load_dwordx4 v5, s[44:47], s10 offen offset:1024 nt lds
    s_waitcnt lgkmcnt(1)
    v_mfma_f32_16x16x32_bf16 v[24:27], v[48:51], v[88:91], v[24:27]
    s_waitcnt lgkmcnt(0)
    v_mfma_f32_16x16x32_bf16 v[24:27], v[52:55], v[92:95], v[24:27]
    s_nop 7
    v_cvt_pk_bf16_f32 v28, 0, v24
    v_cvt_pk_bf16_f32 v29, 0, v25
    v_cvt_pk_bf16_f32 v30, 0, v26
    v_cvt_pk_bf16_f32 v31, 0, v27
    v_max3_f32 v21, v28, v29, v30
    v_max3_f32 v21, v21, v31, v17
    s_add_u32 m0, s101, 4096
    s_waitcnt vmcnt(7)
    buffer_load_dwordx4 v9, s[44:47], s10 offen offset:1024 nt lds
    v_mov_b32 v22, v21
    s_nop 1
    v_permlane32_swap_b32 v21, v22
    v_max_f32 v21, v21, v22
    v_mov_b32 v22, v21
    s_nop 1
    v_permlane16_swap_b32 v21, v22
    v_max_f32 v21, v21, v22
    v_sub_f32 v19, v17, v21
    v_sub_f32 v28, v28, v21
    v_sub_f32 v29, v29, v21
    v_sub_f32 v30, v30, v21
    v_sub_f32 v31, v31, v21
    s_add_u32 m0, s101, 0
    s_waitcnt vmcnt(7)
    buffer_load_dwordx4 v6, s[44:47], s10 offen offset:2048 nt lds
    v_mul_f32 v19, s14, v19
    v_mul_f32 v28, s14, v28
    v_mul_f32 v29, s14, v29
    v_mul_f32 v30, s14, v30
    v_mul_f32 v31, s14, v31
    v_exp_f32 v19, v19
    v_exp_f32 v28, v28
    v_exp_f32 v29, v29
    v_exp_f32 v30, v30
    v_exp_f32 v31, v31
    s_add_u32 m0, s101, 4096
    s_waitcnt vmcnt(7)
    buffer_load_dwordx4 v10, s[44:47], s10 offen offset:2048 nt lds
    v_mov_b32 v17, v21
    v_cvt_pk_bf16_f32 v24, v28, v29
    v_cvt_pk_bf16_f32 v25, v30, v31
    v_add_f32 v21, v28, v29
    v_add_f32 v22, v30, v31
    v_add_f32 v21, v21, v22
    v_fma_f32 v18, v18, v19, v21
    v_mul_f32_dpp v32, v19, v32 quad_perm:[0,0,2,2] row_mask:0xf bank_mask:0xf
    v_mul_f32_dpp v33, v19, v33 quad_perm:[1,1,3,3] row_mask:0xf bank_mask:0xf
    v_mul_f32_dpp v34, v19, v34 quad_perm:[0,0,2,2] row_mask:0xf bank_mask:0xf
    s_add_u32 m0, s101, 0
    s_waitcnt vmcnt(7)
    buffer_load_dwordx4 v7, s[44:47], s10 offen offset:3072 nt lds
    v_mul_f32_dpp v35, v19, v35 quad_perm:[1,1,3,3] row_mask:0xf bank_mask:0xf
    v_mul_f32_dpp v36, v19, v36 quad_perm:[0,0,2,2] row_mask:0xf bank_mask:0xf
    v_mul_f32_dpp v37, v19, v37 quad_perm:[1,1,3,3] row_mask:0xf bank_mask:0xf
    v_mul_f32_dpp v38, v19, v38 quad_perm:[0,0,2,2] row_mask:0xf bank_mask:0xf
    v_mul_f32_dpp v39, v19, v39 quad_perm:[1,1,3,3] row_mask:0xf bank_mask:0xf
    v_cndmask_b32 v40, 0, v24, s[64:65]
    v_cndmask_b32 v41, 0, v25, s[64:65]
    v_cndmask_b32 v42, 0, v24, s[66:67]
    v_cndmask_b32 v43, 0, v25, s[66:67]
    v_cndmask_b32 v44, 0, v24, s[68:69]
    s_add_u32 m0, s101, 4096
    s_waitcnt vmcnt(7)
    buffer_load_dwordx4 v11, s[44:47], s10 offen offset:3072 nt lds
    v_cndmask_b32 v45, 0, v25, s[68:69]
    v_cndmask_b32 v46, 0, v24, s[70:71]
    v_cndmask_b32 v47, 0, v25, s[70:71]
    v_cndmask_b32 v48, 0, v24, s[72:73]
    v_cndmask_b32 v49, 0, v25, s[72:73]
    v_cndmask_b32 v50, 0, v24, s[74:75]
    v_cndmask_b32 v51, 0, v25, s[74:75]
    v_cndmask_b32 v52, 0, v24, s[76:77]
    v_cndmask_b32 v53, 0, v25, s[76:77]
    v_cndmask_b32 v54, 0, v24, s[78:79]
    v_cndmask_b32 v55, 0, v25, s[78:79]
    s_waitcnt vmcnt(8)
    s_waitcnt vmcnt(7)
    buffer_load_dwordx4 v[96:99], v12, s[48:51], s10 offen offset:0 nt
    v_perm_b32 v56, v132, v128, s12
    v_perm_b32 v57, v140, v136, s12
    v_perm_b32 v58, v134, v130, s12
    v_perm_b32 v59, v142, v138, s12
    v_perm_b32 v60, v132, v128, s13
    v_perm_b32 v61, v140, v136, s13
    s_waitcnt vmcnt(7)
    buffer_load_dwordx4 v[100:103], v12, s[48:51], s10 offen offset:512 nt
    v_mfma_f32_16x16x16_bf16 v[32:35], v[40:41], v[56:57], v[32:35]
    v_perm_b32 v62, v134, v130, s13
    v_perm_b32 v63, v142, v138, s13
    v_mfma_f32_16x16x16_bf16 v[36:39], v[40:41], v[58:59], v[36:39]
    v_perm_b32 v56, v133, v129, s12
    v_perm_b32 v57, v141, v137, s12
    s_waitcnt vmcnt(7)
    buffer_load_dwordx4 v[104:107], v12, s[48:51], s10 offen offset:1024 nt
    v_mfma_f32_16x16x16_bf16 v[32:35], v[44:45], v[60:61], v[32:35]
    v_perm_b32 v58, v135, v131, s12
    v_perm_b32 v59, v143, v139, s12
    v_mfma_f32_16x16x16_bf16 v[36:39], v[44:45], v[62:63], v[36:39]
    v_perm_b32 v60, v133, v129, s13
    v_perm_b32 v61, v141, v137, s13
    s_waitcnt vmcnt(7)
    buffer_load_dwordx4 v[108:111], v12, s[48:51], s10 offen offset:1536 nt
    v_mfma_f32_16x16x16_bf16 v[32:35], v[48:49], v[56:57], v[32:35]
    v_perm_b32 v62, v135, v131, s13
    v_perm_b32 v63, v143, v139, s13
    v_mfma_f32_16x16x16_bf16 v[36:39], v[48:49], v[58:59], v[36:39]
    v_perm_b32 v56, v148, v144, s12
    v_perm_b32 v57, v156, v152, s12
    s_waitcnt vmcnt(7)
    buffer_load_dwordx4 v[112:115], v12, s[48:51], s10 offen offset:256 nt
    v_mfma_f32_16x16x16_bf16 v[32:35], v[52:53], v[60:61], v[32:35]
    v_perm_b32 v58, v150, v146, s12
    v_perm_b32 v59, v158, v154, s12
    v_mfma_f32_16x16x16_bf16 v[36:39], v[52:53], v[62:63], v[36:39]
    v_perm_b32 v60, v148, v144, s13
    v_perm_b32 v61, v156, v152, s13
    s_mov_b32 s58, s99
    s_add_u32 s99, s99, 28
    s_cmp_lt_i32 s58, s97
    s_nop 1
    s_cbranch_scc1 L_tk4
    s_mov_b32 s58, 1
    s_atomic_add s58, s[56:57], 0 glc
L_tk4:
    s_waitcnt vmcnt(7)
    buffer_load_dwordx4 v[116:119], v12, s[48:51], s10 offen offset:768 nt
    v_mfma_f32_16x16x16_bf16 v[32:35], v[42:43], v[56:57], v[32:35]
    v_perm_b32 v62, v150, v146, s13
    v_perm_b32 v63, v158, v154, s13
    v_mfma_f32_16x16x16_bf16 v[36:39], v[42:43], v[58:59], v[36:39]
    v_perm_b32 v56, v149, v145, s12
    v_perm_b32 v57, v157, v153, s12
    s_waitcnt vmcnt(7)
    buffer_load_dwordx4 v[120:123], v12, s[48:51], s10 offen offset:1280 nt
    v_mfma_f32_16x16x16_bf16 v[32:35], v[46:47], v[60:61], v[32:35]
    v_perm_b32 v58, v151, v147, s12
    v_perm_b32 v59, v159, v155, s12
    v_mfma_f32_16x16x16_bf16 v[36:39], v[46:47], v[62:63], v[36:39]
    v_perm_b32 v60, v149, v145, s13
    v_perm_b32 v61, v157, v153, s13
    s_waitcnt vmcnt(7)
    buffer_load_dwordx4 v[124:127], v12, s[48:51], s10 offen offset:1792 nt
    v_mfma_f32_16x16x16_bf16 v[32:35], v[50:51], v[56:57], v[32:35]
    v_perm_b32 v62, v151, v147, s13
    v_perm_b32 v63, v159, v155, s13
    v_mfma_f32_16x16x16_bf16 v[36:39], v[50:51], v[58:59], v[36:39]
    v_mfma_f32_16x16x16_bf16 v[32:35], v[54:55], v[60:61], v[32:35]
    v_mfma_f32_16x16x16_bf16 v[36:39], v[54:55], v[62:63], v[36:39]
    s_nop 6
    s_branch L_body0
L_extra:
    s_add_u32 m0, s101, 0
    s_waitcnt vmcnt(3)
    buffer_load_dwordx4 v4, s[44:47], s10 offen offset:0 nt lds
    s_add_u32 m0, s101, 4096
    s_waitcnt vmcnt(3)
    buffer_load_dwordx4 v8, s[44:47], s10 offen offset:0 nt lds
    s_add_u32 m0, s101, 0
    s_waitcnt vmcnt(3)
    buffer_load_dwordx4 v5, s[44:47], s10 offen offset:1024 nt lds
    s_add_u32 m0, s101, 4096
    s_waitcnt vmcnt(3)
    buffer_load_dwordx4 v9, s[44:47], s10 offen offset:1024 nt lds
    s_add_u32 m0, s101, 0
    s_waitcnt vmcnt(3)
    buffer_load_dwordx4 v6, s[44:47], s10 offen offset:2048 nt lds
    s_add_u32 m0, s101, 4096
    s_waitcnt vmcnt(3)
    buffer_load_dwordx4 v10, s[44:47], s10 offen offset:2048 nt lds
    s_add_u32 m0, s101, 0
    s_waitcnt vmcnt(3)
    buffer_load_dwordx4 v7, s[44:47], s10 offen offset:3072 nt lds
    s_add_u32 m0, s101, 4096
    s_waitcnt vmcnt(3)
    buffer_load_dwordx4 v11, s[44:47], s10 offen offset:3072 nt lds
    s_barrier
    s_mov_b32 s52, s42
    s_mov_b32 s53, s43
    s_mov_b32 s54, 1310720
    s_mov_b32 s55, 0x20000
    s_lshl_b32 s9, s4, 10
    s_add_u32 s9, s9, 65536
    s_add_u32 s56, s42, s9
    s_addc_u32 s57, s43, 0
    v_mov_b32 v22, v2
    v_xor_b32 v21, v1, v22
    v_lshlrev_b32 v21, 4, v21
    v_lshl_add_u32 v21, v22, 9, v21
    v_add_u32 v13, s101, v21
    v_xor_b32 v14, 64, v13
    v_xor_b32 v15, 128, v13
    v_xor_b32 v16, 192, v13
    v_lshrrev_b32 v21, 1, v2
    v_cmp_eq_u32 s[64:65], 0, v21
    v_cmp_eq_u32 s[66:67], 1, v21
    v_cmp_eq_u32 s[68:69], 2, v21
    v_cmp_eq_u32 s[70:71], 3, v21
    v_cmp_eq_u32 s[72:73], 4, v21
    v_cmp_eq_u32 s[74:75], 5, v21
    v_cmp_eq_u32 s[76:77], 6, v21
    v_cmp_eq_u32 s[78:79], 7, v21
    v_mov_b32 v17, 0xff800000
    v_mov_b32 v18, 0
    v_mov_b32 v32, 0
    v_mov_b32 v33, 0
    v_mov_b32 v34, 0
    v_mov_b32 v35, 0
    v_mov_b32 v36, 0
    v_mov_b32 v37, 0
    v_mov_b32 v38, 0
    v_mov_b32 v39, 0
    s_add_u32 s10, s10, 8192
    s_waitcnt vmcnt(3)
    buffer_load_dwordx4 v[192:195], v4, s[44:47], s10 offen offset:0 nt
    s_waitcnt vmcnt(3)
    buffer_load_dwordx4 v[208:211], v8, s[44:47], s10 offen offset:0 nt
    s_waitcnt vmcnt(3)
    buffer_load_dwordx4 v[196:199], v5, s[44:47], s10 offen offset:1024 nt
    s_waitcnt vmcnt(3)
    buffer_load_dwordx4 v[212:215], v9, s[44:47], s10 offen offset:1024 nt
    s_waitcnt vmcnt(3)
    buffer_load_dwordx4 v[200:203], v6, s[44:47], s10 offen offset:2048 nt
    s_waitcnt vmcnt(3)
    buffer_load_dwordx4 v[216:219], v10, s[44:47], s10 offen offset:2048 nt
    s_waitcnt vmcnt(3)
    buffer_load_dwordx4 v[204:207], v7, s[44:47], s10 offen offset:3072 nt
    s_waitcnt vmcnt(3)
    buffer_load_dwordx4 v[220:223], v11, s[44:47], s10 offen offset:3072 nt
    s_add_u32 s10, s10, 8192
    s_waitcnt vmcnt(3)
    buffer_load_dwordx4 v[224:227], v4, s[44:47], s10 offen offset:0 nt
    s_waitcnt vmcnt(3)
    buffer_load_dwordx4 v[240:243], v8, s[44:47], s10 offen offset:0 nt
    s_waitcnt vmcnt(3)
    buffer_load_dwordx4 v[228:231], v5, s[44:47], s10 offen offset:1024 nt
    s_waitcnt vmcnt(3)
    buffer_load_dwordx4 v[244:247], v9, s[44:47], s10 offen offset:1024 nt
    s_waitcnt vmcnt(3)
    buffer_load_dwordx4 v[232:235], v6, s[44:47], s10 offen offset:2048 nt
    s_waitcnt vmcnt(3)
    buffer_load_dwordx4 v[248:251], v10, s[44:47], s10 offen offset:2048 nt
    s_waitcnt vmcnt(3)
    buffer_load_dwordx4 v[236:239], v7, s[44:47], s10 offen offset:3072 nt
    s_waitcnt vmcnt(3)
    buffer_load_dwordx4 v[252:255], v11, s[44:47], s10 offen offset:3072 nt
    s_sub_u32 s10, s10, 16384
    s_waitcnt vmcnt(3)
    buffer_load_dwordx4 v[96:99], v12, s[48:51], s10 offen offset:0 nt
    s_waitcnt vmcnt(3)
    buffer_load_dwordx4 v[100:103], v12, s[48:51], s10 offen offset:512 nt
    s_waitcnt vmcnt(3)
    buffer_load_dwordx4 v[104:107], v12, s[48:51], s10 offen offset:1024 nt
    s_waitcnt vmcnt(3)
    buffer_load_dwordx4 v[108:111], v12, s[48:51], s10 offen offset:1536 nt
    s_waitcnt vmcnt(3)
    buffer_load_dwordx4 v[112:115], v12, s[48:51], s10 offen offset:256 nt
    s_waitcnt vmcnt(3)
    buffer_load_dwordx4 v[116:119], v12, s[48:51], s10 offen offset:768 nt
    s_waitcnt vmcnt(3)
    buffer_load_dwordx4 v[120:123], v12, s[48:51], s10 offen offset:1280 nt
    s_waitcnt vmcnt(3)
    buffer_load_dwordx4 v[124:127], v12, s[48:51], s10 offen offset:1792 nt
    s_add_u32 s10, s10, 8192
    s_waitcnt vmcnt(3)
    buffer_load_dwordx4 v[128:131], v12, s[48:51], s10 offen offset:0 nt
    s_waitcnt vmcnt(3)
    buffer_load_dwordx4 v[132:135], v12, s[48:51], s10 offen offset:512 nt
    s_waitcnt vmcnt(3)
    buffer_load_dwordx4 v[136:139], v12, s[48:51], s10 offen offset:1024 nt
    s_waitcnt vmcnt(3)
    buffer_load_dwordx4 v[140:143], v12, s[48:51], s10 offen offset:1536 nt
    s_waitcnt vmcnt(3)
    buffer_load_dwordx4 v[144:147], v12, s[48:51], s10 offen offset:256 nt
    s_waitcnt vmcnt(3)
    buffer_load_dwordx4 v[148:151], v12, s[48:51], s10 offen offset:768 nt
    s_waitcnt vmcnt(3)
    buffer_load_dwordx4 v[152:155], v12, s[48:51], s10 offen offset:1280 nt
    s_waitcnt vmcnt(3)
    buffer_load_dwordx4 v[156:159], v12, s[48:51], s10 offen offset:1792 nt
    s_add_u32 s10, s10, 8192
    s_waitcnt vmcnt(3)
    buffer_load_dwordx4 v[160:163], v12, s[48:51], s10 offen offset:0 nt
    s_waitcnt vmcnt(3)
    buffer_load_dwordx4 v[164:167], v12, s[48:51], s10 offen offset:512 nt
    s_waitcnt vmcnt(3)
    buffer_load_dwordx4 v[168:171], v12, s[48:51], s10 offen offset:1024 nt
    s_waitcnt vmcnt(3)
    buffer_load_dwordx4 v[172:175], v12, s[48:51], s10 offen offset:1536 nt
    s_waitcnt vmcnt(3)
    buffer_load_dwordx4 v[176:179], v12, s[48:51], s10 offen offset:256 nt
    s_waitcnt vmcnt(3)
    buffer_load_dwordx4 v[180:183], v12, s[48:51], s10 offen offset:768 nt
    s_waitcnt vmcnt(3)
    buffer_load_dwordx4 v[184:187], v12, s[48:51], s10 offen offset:1280 nt
    s_waitcnt vmcnt(3)
    buffer_load_dwordx4 v[188:191], v12, s[48:51], s10 offen offset:1792 nt
    s_add_u32 s10, s10, 8192
    v_and_b32 v21, 1, v2
    v_lshlrev_b32 v21, 9, v21
    v_lshl_add_u32 v21, v1, 4, v21
    v_add_u32 v21, 147456, v21
    v_mov_b32 v22, 148480
    s_mov_b32 s15, 0
L_qw5:
    ds_read_b32 v19, v22
    s_waitcnt lgkmcnt(0)
    v_cmp_eq_u32 vcc, 0, v19
    s_nop 0
    s_cbranch_vccz L_qw5_ok
    s_sleep 2
    s_add_u32 s15, s15, 1
    s_cmp_lt_u32 s15, 16000000
    s_cbranch_scc1 L_qw5
L_qw5_ok:
    ds_read_b128 v[64:67], v21 offset:0
    ds_read_b128 v[68:71], v21 offset:64
    ds_read_b128 v[72:75], v21 offset:128
    ds_read_b128 v[76:79], v21 offset:192
    ds_read_b128 v[80:83], v21 offset:256
    ds_read_b128 v[84:87], v21 offset:320
    ds_read_b128 v[88:91], v21 offset:384
    ds_read_b128 v[92:95], v21 offset:448
    s_waitcnt lgkmcnt(0)
    ds_read_b128 v[40:43], v13 offset:0
    ds_read_b128 v[44:47], v14 offset:0
    ds_read_b128 v[48:51], v15 offset:0
    ds_read_b128 v[52:55], v16 offset:0
    s_waitcnt lgkmcnt(3)
    v_mfma_f32_16x16x32_bf16 v[24:27], v[40:43], v[64:67], 0
    ds_read_b128 v[40:43], v13 offset:256
    s_waitcnt lgkmcnt(3)
    v_mfma_f32_16x16x32_bf16 v[24:27], v[44:47], v[68:71], v[24:27]
    ds_read_b128 v[44:47], v14 offset:256
    s_waitcnt lgkmcnt(3)
    v_mfma_f32_16x16x32_bf16 v[24:27], v[48:51], v[72:75], v[24:27]
    ds_read_b128 v[48:51], v15 offset:256
    s_waitcnt lgkmcnt(3)
    v_mfma_f32_16x16x32_bf16 v[24:27], v[52:55], v[76:79], v[24:27]
    ds_read_b128 v[52:55], v16 offset:256
    s_waitcnt lgkmcnt(3)
    v_mfma_f32_16x16x32_bf16 v[24:27], v[40:43], v[80:83], v[24:27]
    s_waitcnt lgkmcnt(2)
    v_mfma_f32_16x16x32_bf16 v[24:27], v[44:47], v[84:87], v[24:27]
    s_waitcnt lgkmcnt(1)
    v_mfma_f32_16x16x32_bf16 v[24:27], v[48:51], v[88:91], v[24:27]
    s_waitcnt lgkmcnt(0)
    v_mfma_f32_16x16x32_bf16 v[24:27], v[52:55], v[92:95], v[24:27]
    s_nop 7
    v_cvt_pk_bf16_f32 v28, 0, v24
    v_cvt_pk_bf16_f32 v29, 0, v25
    v_cvt_pk_bf16_f32 v30, 0, v26
    v_cvt_pk_bf16_f32 v31, 0, v27
    v_max3_f32 v21, v28, v29, v30
    v_max3_f32 v21, v21, v31, v17
    v_mov_b32 v22, v21
    s_nop 1
    v_permlane32_swap_b32 v21, v22
    v_max_f32 v21, v21, v22
    v_mov_b32 v22, v21
    s_nop 1
    v_permlane16_swap_b32 v21, v22
    v_max_f32 v21, v21, v22
    v_sub_f32 v19, v17, v21
    v_sub_f32 v28, v28, v21
    v_sub_f32 v29, v29, v21
    v_sub_f32 v30, v30, v21
    v_sub_f32 v31, v31, v21
    v_mul_f32 v19, s14, v19
    v_mul_f32 v28, s14, v28
    v_mul_f32 v29, s14, v29
    v_mul_f32 v30, s14, v30
    v_mul_f32 v31, s14, v31
    v_exp_f32 v19, v19
    v_exp_f32 v28, v28
    v_exp_f32 v29, v29
    v_exp_f32 v30, v30
    v_exp_f32 v31, v31
    v_mov_b32 v17, v21
    v_cvt_pk_bf16_f32 v24, v28, v29
    v_cvt_pk_bf16_f32 v25, v30, v31
    v_add_f32 v21, v28, v29
    v_add_f32 v22, v30, v31
    v_add_f32 v21, v21, v22
    v_fma_f32 v18, v18, v19, v21
    v_mul_f32_dpp v32, v19, v32 quad_perm:[0,0,2,2] row_mask:0xf bank_mask:0xf
    v_mul_f32_dpp v33, v19, v33 quad_perm:[1,1,3,3] row_mask:0xf bank_mask:0xf
    v_mul_f32_dpp v34, v19, v34 quad_perm:[0,0,2,2] row_mask:0xf bank_mask:0xf
    v_mul_f32_dpp v35, v19, v35 quad_perm:[1,1,3,3] row_mask:0xf bank_mask:0xf
    v_mul_f32_dpp v36, v19, v36 quad_perm:[0,0,2,2] row_mask:0xf bank_mask:0xf
    v_mul_f32_dpp v37, v19, v37 quad_perm:[1,1,3,3] row_mask:0xf bank_mask:0xf
    v_mul_f32_dpp v38, v19, v38 quad_perm:[0,0,2,2] row_mask:0xf bank_mask:0xf
    v_mul_f32_dpp v39, v19, v39 quad_perm:[1,1,3,3] row_mask:0xf bank_mask:0xf
    v_cndmask_b32 v40, 0, v24, s[64:65]
    v_cndmask_b32 v41, 0, v25, s[64:65]
    v_cndmask_b32 v42, 0, v24, s[66:67]
    v_cndmask_b32 v43, 0, v25, s[66:67]
    v_cndmask_b32 v44, 0, v24, s[68:69]
    v_cndmask_b32 v45, 0, v25, s[68:69]
    v_cndmask_b32 v46, 0, v24, s[70:71]
    v_cndmask_b32 v47, 0, v25, s[70:71]
    v_cndmask_b32 v48, 0, v24, s[72:73]
    v_cndmask_b32 v49, 0, v25, s[72:73]
    v_cndmask_b32 v50, 0, v24, s[74:75]
    v_cndmask_b32 v51, 0, v25, s[74:75]
    v_cndmask_b32 v52, 0, v24, s[76:77]
    v_cndmask_b32 v53, 0, v25, s[76:77]
    v_cndmask_b32 v54, 0, v24, s[78:79]
    v_cndmask_b32 v55, 0, v25, s[78:79]
    v_perm_b32 v56, v100, v96, s12
    v_perm_b32 v57, v108, v104, s12
    v_perm_b32 v58, v102, v98, s12
    v_perm_b32 v59, v110, v106, s12
    v_perm_b32 v60, v100, v96, s13
    v_perm_b32 v61, v108, v104, s13
    v_mfma_f32_16x16x16_bf16 v[32:35], v[40:41], v[56:57], v[32:35]
    v_perm_b32 v62, v102, v98, s13
    v_perm_b32 v63, v110, v106, s13
    v_mfma_f32_16x16x16_bf16 v[36:39], v[40:41], v[58:59], v[36:39]
    v_perm_b32 v56, v101, v97, s12
    v_perm_b32 v57, v109, v105, s12
    v_mfma_f32_16x16x16_bf16 v[32:35], v[44:45], v[60:61], v[32:35]
    v_perm_b32 v58, v103, v99, s12
    v_perm_b32 v59, v111, v107, s12
    v_mfma_f32_16x16x16_bf16 v[36:39], v[44:45], v[62:63], v[36:39]
    v_perm_b32 v60, v101, v97, s13
    v_perm_b32 v61, v109, v105, s13
    v_mfma_f32_16x16x16_bf16 v[32:35], v[48:49], v[56:57], v[32:35]
    v_perm_b32 v62, v103, v99, s13
    v_perm_b32 v63, v111, v107, s13
    v_mfma_f32_16x16x16_bf16 v[36:39], v[48:49], v[58:59], v[36:39]
    v_perm_b32 v56, v116, v112, s12
    v_perm_b32 v57, v124, v120, s12
    v_mfma_f32_16x16x16_bf16 v[32:35], v[52:53], v[60:61], v[32:35]
    v_perm_b32 v58, v118, v114, s12
    v_perm_b32 v59, v126, v122, s12
    v_mfma_f32_16x16x16_bf16 v[36:39], v[52:53], v[62:63], v[36:39]
    v_perm_b32 v60, v116, v112, s13
    v_perm_b32 v61, v124, v120, s13
    v_mfma_f32_16x16x16_bf16 v[32:35], v[42:43], v[56:57], v[32:35]
    v_perm_b32 v62, v118, v114, s13
    v_perm_b32 v63, v126, v122, s13
    v_mfma_f32_16x16x16_bf16 v[36:39], v[42:43], v[58:59], v[36:39]
    v_perm_b32 v56, v117, v113, s12
    v_perm_b32 v57, v125, v121, s12
    v_mfma_f32_16x16x16_bf16 v[32:35], v[46:47], v[60:61], v[32:35]
    v_perm_b32 v58, v119, v115, s12
    v_perm_b32 v59, v127, v123, s12
    v_mfma_f32_16x16x16_bf16 v[36:39], v[46:47], v[62:63], v[36:39]
    v_perm_b32 v60, v117, v113, s13
    v_perm_b32 v61, v125, v121, s13
    v_mfma_f32_16x16x16_bf16 v[32:35], v[50:51], v[56:57], v[32:35]
    v_perm_b32 v62, v119, v115, s13
    v_perm_b32 v63, v127, v123, s13
    v_mfma_f32_16x16x16_bf16 v[36:39], v[50:51], v[58:59], v[36:39]
    v_mfma_f32_16x16x16_bf16 v[32:35], v[54:55], v[60:61], v[32:35]
    v_mfma_f32_16x16x16_bf16 v[36:39], v[54:55], v[62:63], v[36:39]
    v_lshl_add_u32 v21, v0, 4, s101
    s_waitcnt vmcnt(8)
    ds_write_b128 v21, v[192:195] offset:0
    ds_write_b128 v21, v[196:199] offset:1024
    ds_write_b128 v21, v[200:203] offset:2048
    ds_write_b128 v21, v[204:207] offset:3072
    ds_write_b128 v21, v[208:211] offset:4096
    ds_write_b128 v21, v[212:215] offset:5120
    ds_write_b128 v21, v[216:219] offset:6144
    ds_write_b128 v21, v[220:223] offset:7168
    s_waitcnt lgkmcnt(0)
    ds_read_b128 v[40:43], v13 offset:0
    ds_read_b128 v[44:47], v14 offset:0
    ds_read_b128 v[48:51], v15 offset:0
    ds_read_b128 v[52:55], v16 offset:0
    s_waitcnt lgkmcnt(3)
    v_mfma_f32_16x16x32_bf16 v[24:27], v[40:43], v[64:67], 0
    ds_read_b128 v[40:43], v13 offset:256
    s_waitcnt lgkmcnt(3)
    v_mfma_f32_16x16x32_bf16 v[24:27], v[44:47], v[68:71], v[24:27]
    ds_read_b128 v[44:47], v14 offset:256
    s_waitcnt lgkmcnt(3)
    v_mfma_f32_16x16x32_bf16 v[24:27], v[48:51], v[72:75], v[24:27]
    ds_read_b128 v[48:51], v15 offset:256
    s_waitcnt lgkmcnt(3)
    v_mfma_f32_16x16x32_bf16 v[24:27], v[52:55], v[76:79], v[24:27]
    ds_read_b128 v[52:55], v16 offset:256
    s_waitcnt lgkmcnt(3)
    v_mfma_f32_16x16x32_bf16 v[24:27], v[40:43], v[80:83], v[24:27]
    s_waitcnt lgkmcnt(2)
    v_mfma_f32_16x16x32_bf16 v[24:27], v[44:47], v[84:87], v[24:27]
    s_waitcnt lgkmcnt(1)
    v_mfma_f32_16x16x32_bf16 v[24:27], v[48:51], v[88:91], v[24:27]
    s_waitcnt lgkmcnt(0)
    v_mfma_f32_16x16x32_bf16 v[24:27], v[52:55], v[92:95], v[24:27]
    s_nop 7
    v_cvt_pk_bf16_f32 v28, 0, v24
    v_cvt_pk_bf16_f32 v29, 0, v25
    v_cvt_pk_bf16_f32 v30, 0, v26
    v_cvt_pk_bf16_f32 v31, 0, v27
    v_max3_f32 v21, v28, v29, v30
    v_max3_f32 v21, v21, v31, v17
    v_mov_b32 v22, v21
    s_nop 1
    v_permlane32_swap_b32 v21, v22
    v_max_f32 v21, v21, v22
    v_mov_b32 v22, v21
    s_nop 1
    v_permlane16_swap_b32 v21, v22
    v_max_f32 v21, v21, v22
    v_sub_f32 v19, v17, v21
    v_sub_f32 v28, v28, v21
    v_sub_f32 v29, v29, v21
    v_sub_f32 v30, v30, v21
    v_sub_f32 v31, v31, v21
    v_mul_f32 v19, s14, v19
    v_mul_f32 v28, s14, v28
    v_mul_f32 v29, s14, v29
    v_mul_f32 v30, s14, v30
    v_mul_f32 v31, s14, v31
    v_exp_f32 v19, v19
    v_exp_f32 v28, v28
    v_exp_f32 v29, v29
    v_exp_f32 v30, v30
    v_exp_f32 v31, v31
    v_mov_b32 v17, v21
    v_cvt_pk_bf16_f32 v24, v28, v29
    v_cvt_pk_bf16_f32 v25, v30, v31
    v_add_f32 v21, v28, v29
    v_add_f32 v22, v30, v31
    v_add_f32 v21, v21, v22
    v_fma_f32 v18, v18, v19, v21
    v_mul_f32_dpp v32, v19, v32 quad_perm:[0,0,2,2] row_mask:0xf bank_mask:0xf
    v_mul_f32_dpp v33, v19, v33 quad_perm:[1,1,3,3] row_mask:0xf bank_mask:0xf
    v_mul_f32_dpp v34, v19, v34 quad_perm:[0,0,2,2] row_mask:0xf bank_mask:0xf
    v_mul_f32_dpp v35, v19, v35 quad_perm:[1,1,3,3] row_mask:0xf bank_mask:0xf
    v_mul_f32_dpp v36, v19, v36 quad_perm:[0,0,2,2] row_mask:0xf bank_mask:0xf
    v_mul_f32_dpp v37, v19, v37 quad_perm:[1,1,3,3] row_mask:0xf bank_mask:0xf
    v_mul_f32_dpp v38, v19, v38 quad_perm:[0,0,2,2] row_mask:0xf bank_mask:0xf
    v_mul_f32_dpp v39, v19, v39 quad_perm:[1,1,3,3] row_mask:0xf bank_mask:0xf
    v_cndmask_b32 v40, 0, v24, s[64:65]
    v_cndmask_b32 v41, 0, v25, s[64:65]
    v_cndmask_b32 v42, 0, v24, s[66:67]
    v_cndmask_b32 v43, 0, v25, s[66:67]
    v_cndmask_b32 v44, 0, v24, s[68:69]
    v_cndmask_b32 v45, 0, v25, s[68:69]
    v_cndmask_b32 v46, 0, v24, s[70:71]
    v_cndmask_b32 v47, 0, v25, s[70:71]
    v_cndmask_b32 v48, 0, v24, s[72:73]
    v_cndmask_b32 v49, 0, v25, s[72:73]
    v_cndmask_b32 v50, 0, v24, s[74:75]
    v_cndmask_b32 v51, 0, v25, s[74:75]
    v_cndmask_b32 v52, 0, v24, s[76:77]
    v_cndmask_b32 v53, 0, v25, s[76:77]
    v_cndmask_b32 v54, 0, v24, s[78:79]
    v_cndmask_b32 v55, 0, v25, s[78:79]
    v_perm_b32 v56, v132, v128, s12
    v_perm_b32 v57, v140, v136, s12
    v_perm_b32 v58, v134, v130, s12
    v_perm_b32 v59, v142, v138, s12
    v_perm_b32 v60, v132, v128, s13
    v_perm_b32 v61, v140, v136, s13
    v_mfma_f32_16x16x16_bf16 v[32:35], v[40:41], v[56:57], v[32:35]
    v_perm_b32 v62, v134, v130, s13
    v_perm_b32 v63, v142, v138, s13
    v_mfma_f32_16x16x16_bf16 v[36:39], v[40:41], v[58:59], v[36:39]
    v_perm_b32 v56, v133, v129, s12
    v_perm_b32 v57, v141, v137, s12
    v_mfma_f32_16x16x16_bf16 v[32:35], v[44:45], v[60:61], v[32:35]
    v_perm_b32 v58, v135, v131, s12
    v_perm_b32 v59, v143, v139, s12
    v_mfma_f32_16x16x16_bf16 v[36:39], v[44:45], v[62:63], v[36:39]
    v_perm_b32 v60, v133, v129, s13
    v_perm_b32 v61, v141, v137, s13
    v_mfma_f32_16x16x16_bf16 v[32:35], v[48:49], v[56:57], v[32:35]
    v_perm_b32 v62, v135, v131, s13
    v_perm_b32 v63, v143, v139, s13
    v_mfma_f32_16x16x16_bf16 v[36:39], v[48:49], v[58:59], v[36:39]
    v_perm_b32 v56, v148, v144, s12
    v_perm_b32 v57, v156, v152, s12
    v_mfma_f32_16x16x16_bf16 v[32:35], v[52:53], v[60:61], v[32:35]
    v_perm_b32 v58, v150, v146, s12
    v_perm_b32 v59, v158, v154, s12
    v_mfma_f32_16x16x16_bf16 v[36:39], v[52:53], v[62:63], v[36:39]
    v_perm_b32 v60, v148, v144, s13
    v_perm_b32 v61, v156, v152, s13
    v_mfma_f32_16x16x16_bf16 v[32:35], v[42:43], v[56:57], v[32:35]
    v_perm_b32 v62, v150, v146, s13
    v_perm_b32 v63, v158, v154, s13
    v_mfma_f32_16x16x16_bf16 v[36:39], v[42:43], v[58:59], v[36:39]
    v_perm_b32 v56, v149, v145, s12
    v_perm_b32 v57, v157, v153, s12
    v_mfma_f32_16x16x16_bf16 v[32:35], v[46:47], v[60:61], v[32:35]
    v_perm_b32 v58, v151, v147, s12
    v_perm_b32 v59, v159, v155, s12
    v_mfma_f32_16x16x16_bf16 v[36:39], v[46:47], v[62:63], v[36:39]
    v_perm_b32 v60, v149, v145, s13
    v_perm_b32 v61, v157, v153, s13
    v_mfma_f32_16x16x16_bf16 v[32:35], v[50:51], v[56:57], v[32:35]
    v_perm_b32 v62, v151, v147, s13
    v_perm_b32 v63, v159, v155, s13
    v_mfma_f32_16x16x16_bf16 v[36:39], v[50:51], v[58:59], v[36:39]
    v_mfma_f32_16x16x16_bf16 v[32:35], v[54:55], v[60:61], v[32:35]
    v_mfma_f32_16x16x16_bf16 v[36:39], v[54:55], v[62:63], v[36:39]
    v_lshl_add_u32 v21, v0, 4, s101
    s_waitcnt vmcnt(8)
    ds_write_b128 v21, v[224:227] offset:0
    ds_write_b128 v21, v[228:231] offset:1024
    ds_write_b128 v21, v[232:235] offset:2048
    ds_write_b128 v21, v[236:239] offset:3072
    ds_write_b128 v21, v[240:243] offset:4096
    ds_write_b128 v21, v[244:247] offset:5120
    ds_write_b128 v21, v[248:251] offset:6144
    ds_write_b128 v21, v[252:255] offset:7168
    s_waitcnt lgkmcnt(0)
    ds_read_b128 v[40:43], v13 offset:0
    ds_read_b128 v[44:47], v14 offset:0
    ds_read_b128 v[48:51], v15 offset:0
    ds_read_b128 v[52:55], v16 offset:0
    s_waitcnt lgkmcnt(3)
    v_mfma_f32_16x16x32_bf16 v[24:27], v[40:43], v[64:67], 0
    ds_read_b128 v[40:43], v13 offset:256
    s_waitcnt lgkmcnt(3)
    v_mfma_f32_16x16x32_bf16 v[24:27], v[44:47], v[68:71], v[24:27]
    ds_read_b128 v[44:47], v14 offset:256
    s_waitcnt lgkmcnt(3)
    v_mfma_f32_16x16x32_bf16 v[24:27], v[48:51], v[72:75], v[24:27]
    ds_read_b128 v[48:51], v15 offset:256
    s_waitcnt lgkmcnt(3)
    v_mfma_f32_16x16x32_bf16 v[24:27], v[52:55], v[76:79], v[24:27]
    ds_read_b128 v[52:55], v16 offset:256
    s_waitcnt lgkmcnt(3)
    v_mfma_f32_16x16x32_bf16 v[24:27], v[40:43], v[80:83], v[24:27]
    s_waitcnt lgkmcnt(2)
    v_mfma_f32_16x16x32_bf16 v[24:27], v[44:47], v[84:87], v[24:27]
    s_waitcnt lgkmcnt(1)
    v_mfma_f32_16x16x32_bf16 v[24:27], v[48:51], v[88:91], v[24:27]
    s_waitcnt lgkmcnt(0)
    v_mfma_f32_16x16x32_bf16 v[24:27], v[52:55], v[92:95], v[24:27]
    s_nop 7
    v_cvt_pk_bf16_f32 v28, 0, v24
    v_cvt_pk_bf16_f32 v29, 0, v25
    v_cvt_pk_bf16_f32 v30, 0, v26
    v_cvt_pk_bf16_f32 v31, 0, v27
    v_max3_f32 v21, v28, v29, v30
    v_max3_f32 v21, v21, v31, v17
    v_mov_b32 v22, v21
    s_nop 1
    v_permlane32_swap_b32 v21, v22
    v_max_f32 v21, v21, v22
    v_mov_b32 v22, v21
    s_nop 1
    v_permlane16_swap_b32 v21, v22
    v_max_f32 v21, v21, v22
    v_sub_f32 v19, v17, v21
    v_sub_f32 v28, v28, v21
    v_sub_f32 v29, v29, v21
    v_sub_f32 v30, v30, v21
    v_sub_f32 v31, v31, v21
    v_mul_f32 v19, s14, v19
    v_mul_f32 v28, s14, v28
    v_mul_f32 v29, s14, v29
    v_mul_f32 v30, s14, v30
    v_mul_f32 v31, s14, v31
    v_exp_f32 v19, v19
    v_exp_f32 v28, v28
    v_exp_f32 v29, v29
    v_exp_f32 v30, v30
    v_exp_f32 v31, v31
    v_mov_b32 v17, v21
    v_cvt_pk_bf16_f32 v24, v28, v29
    v_cvt_pk_bf16_f32 v25, v30, v31
    v_add_f32 v21, v28, v29
    v_add_f32 v22, v30, v31
    v_add_f32 v21, v21, v22
    v_fma_f32 v18, v18, v19, v21
    v_mul_f32_dpp v32, v19, v32 quad_perm:[0,0,2,2] row_mask:0xf bank_mask:0xf
    v_mul_f32_dpp v33, v19, v33 quad_perm:[1,1,3,3] row_mask:0xf bank_mask:0xf
    v_mul_f32_dpp v34, v19, v34 quad_perm:[0,0,2,2] row_mask:0xf bank_mask:0xf
    v_mul_f32_dpp v35, v19, v35 quad_perm:[1,1,3,3] row_mask:0xf bank_mask:0xf
    v_mul_f32_dpp v36, v19, v36 quad_perm:[0,0,2,2] row_mask:0xf bank_mask:0xf
    v_mul_f32_dpp v37, v19, v37 quad_perm:[1,1,3,3] row_mask:0xf bank_mask:0xf
    v_mul_f32_dpp v38, v19, v38 quad_perm:[0,0,2,2] row_mask:0xf bank_mask:0xf
    v_mul_f32_dpp v39, v19, v39 quad_perm:[1,1,3,3] row_mask:0xf bank_mask:0xf
    v_cndmask_b32 v40, 0, v24, s[64:65]
    v_cndmask_b32 v41, 0, v25, s[64:65]
    v_cndmask_b32 v42, 0, v24, s[66:67]
    v_cndmask_b32 v43, 0, v25, s[66:67]
    v_cndmask_b32 v44, 0, v24, s[68:69]
    v_cndmask_b32 v45, 0, v25, s[68:69]
    v_cndmask_b32 v46, 0, v24, s[70:71]
    v_cndmask_b32 v47, 0, v25, s[70:71]
    v_cndmask_b32 v48, 0, v24, s[72:73]
    v_cndmask_b32 v49, 0, v25, s[72:73]
    v_cndmask_b32 v50, 0, v24, s[74:75]
    v_cndmask_b32 v51, 0, v25, s[74:75]
    v_cndmask_b32 v52, 0, v24, s[76:77]
    v_cndmask_b32 v53, 0, v25, s[76:77]
    v_cndmask_b32 v54, 0, v24, s[78:79]
    v_cndmask_b32 v55, 0, v25, s[78:79]
    s_waitcnt vmcnt(4)
    v_perm_b32 v56, v164, v160, s12
    v_perm_b32 v57, v172, v168, s12
    v_perm_b32 v58, v166, v162, s12
    v_perm_b32 v59, v174, v170, s12
    v_perm_b32 v60, v164, v160, s13
    v_perm_b32 v61, v172, v168, s13
    v_mfma_f32_16x16x16_bf16 v[32:35], v[40:41], v[56:57], v[32:35]
    v_perm_b32 v62, v166, v162, s13
    v_perm_b32 v63, v174, v170, s13
    v_mfma_f32_16x16x16_bf16 v[36:39], v[40:41], v[58:59], v[36:39]
    v_perm_b32 v56, v165, v161, s12
    v_perm_b32 v57, v173, v169, s12
    v_mfma_f32_16x16x16_bf16 v[32:35], v[44:45], v[60:61], v[32:35]
    v_perm_b32 v58, v167, v163, s12
    v_perm_b32 v59, v175, v171, s12
    v_mfma_f32_16x16x16_bf16 v[36:39], v[44:45], v[62:63], v[36:39]
    v_perm_b32 v60, v165, v161, s13
    v_perm_b32 v61, v173, v169, s13
    v_mfma_f32_16x16x16_bf16 v[32:35], v[48:49], v[56:57], v[32:35]
    v_perm_b32 v62, v167, v163, s13
    v_perm_b32 v63, v175, v171, s13
    v_mfma_f32_16x16x16_bf16 v[36:39], v[48:49], v[58:59], v[36:39]
    s_waitcnt vmcnt(0)
    v_perm_b32 v56, v180, v176, s12
    v_perm_b32 v57, v188, v184, s12
    v_mfma_f32_16x16x16_bf16 v[32:35], v[52:53], v[60:61], v[32:35]
    v_perm_b32 v58, v182, v178, s12
    v_perm_b32 v59, v190, v186, s12
    v_mfma_f32_16x16x16_bf16 v[36:39], v[52:53], v[62:63], v[36:39]
    v_perm_b32 v60, v180, v176, s13
    v_perm_b32 v61, v188, v184, s13
    v_mfma_f32_16x16x16_bf16 v[32:35], v[42:43], v[56:57], v[32:35]
    v_perm_b32 v62, v182, v178, s13
    v_perm_b32 v63, v190, v186, s13
    v_mfma_f32_16x16x16_bf16 v[36:39], v[42:43], v[58:59], v[36:39]
    v_perm_b32 v56, v181, v177, s12
    v_perm_b32 v57, v189, v185, s12
    v_mfma_f32_16x16x16_bf16 v[32:35], v[46:47], v[60:61], v[32:35]
    v_perm_b32 v58, v183, v179, s12
    v_perm_b32 v59, v191, v187, s12
    v_mfma_f32_16x16x16_bf16 v[36:39], v[46:47], v[62:63], v[36:39]
    v_perm_b32 v60, v181, v177, s13
    v_perm_b32 v61, v189, v185, s13
    v_mfma_f32_16x16x16_bf16 v[32:35], v[50:51], v[56:57], v[32:35]
    v_perm_b32 v62, v183, v179, s13
    v_perm_b32 v63, v191, v187, s13
    v_mfma_f32_16x16x16_bf16 v[36:39], v[50:51], v[58:59], v[36:39]
    v_mfma_f32_16x16x16_bf16 v[32:35], v[54:55], v[60:61], v[32:35]
    v_mfma_f32_16x16x16_bf16 v[36:39], v[54:55], v[62:63], v[36:39]
    s_nop 6
    s_branch L_dst1
L_drain0:
    s_waitcnt vmcnt(8)
    ds_read_b128 v[40:43], v13 offset:0
    ds_read_b128 v[44:47], v14 offset:0
    ds_read_b128 v[48:51], v15 offset:0
    ds_read_b128 v[52:55], v16 offset:0
    s_waitcnt lgkmcnt(3)
    v_mfma_f32_16x16x32_bf16 v[24:27], v[40:43], v[64:67], 0
    ds_read_b128 v[40:43], v13 offset:256
    s_waitcnt lgkmcnt(3)
    v_mfma_f32_16x16x32_bf16 v[24:27], v[44:47], v[68:71], v[24:27]
    ds_read_b128 v[44:47], v14 offset:256
    s_waitcnt lgkmcnt(3)
    v_mfma_f32_16x16x32_bf16 v[24:27], v[48:51], v[72:75], v[24:27]
    ds_read_b128 v[48:51], v15 offset:256
    s_waitcnt lgkmcnt(3)
    v_mfma_f32_16x16x32_bf16 v[24:27], v[52:55], v[76:79], v[24:27]
    ds_read_b128 v[52:55], v16 offset:256
    s_waitcnt lgkmcnt(3)
    v_mfma_f32_16x16x32_bf16 v[24:27], v[40:43], v[80:83], v[24:27]
    s_waitcnt lgkmcnt(2)
    v_mfma_f32_16x16x32_bf16 v[24:27], v[44:47], v[84:87], v[24:27]
    s_waitcnt lgkmcnt(1)
    v_mfma_f32_16x16x32_bf16 v[24:27], v[48:51], v[88:91], v[24:27]
    s_waitcnt lgkmcnt(0)
    v_mfma_f32_16x16x32_bf16 v[24:27], v[52:55], v[92:95], v[24:27]
    s_nop 7
    v_cvt_pk_bf16_f32 v28, 0, v24
    v_cvt_pk_bf16_f32 v29, 0, v25
    v_cvt_pk_bf16_f32 v30, 0, v26
    v_cvt_pk_bf16_f32 v31, 0, v27
    v_max3_f32 v21, v28, v29, v30
    v_max3_f32 v21, v21, v31, v17
    v_mov_b32 v22, v21
    s_nop 1
    v_permlane32_swap_b32 v21, v22
    v_max_f32 v21, v21, v22
    v_mov_b32 v22, v21
    s_nop 1
    v_permlane16_swap_b32 v21, v22
    v_max_f32 v21, v21, v22
    v_sub_f32 v19, v17, v21
    v_sub_f32 v28, v28, v21
    v_sub_f32 v29, v29, v21
    v_sub_f32 v30, v30, v21
    v_sub_f32 v31, v31, v21
    v_mul_f32 v19, s14, v19
    v_mul_f32 v28, s14, v28
    v_mul_f32 v29, s14, v29
    v_mul_f32 v30, s14, v30
    v_mul_f32 v31, s14, v31
    v_exp_f32 v19, v19
    v_exp_f32 v28, v28
    v_exp_f32 v29, v29
    v_exp_f32 v30, v30
    v_exp_f32 v31, v31
    v_mov_b32 v17, v21
    v_cvt_pk_bf16_f32 v24, v28, v29
    v_cvt_pk_bf16_f32 v25, v30, v31
    v_add_f32 v21, v28, v29
    v_add_f32 v22, v30, v31
    v_add_f32 v21, v21, v22
    v_fma_f32 v18, v18, v19, v21
    v_mul_f32_dpp v32, v19, v32 quad_perm:[0,0,2,2] row_mask:0xf bank_mask:0xf
    v_mul_f32_dpp v33, v19, v33 quad_perm:[1,1,3,3] row_mask:0xf bank_mask:0xf
    v_mul_f32_dpp v34, v19, v34 quad_perm:[0,0,2,2] row_mask:0xf bank_mask:0xf
    v_mul_f32_dpp v35, v19, v35 quad_perm:[1,1,3,3] row_mask:0xf bank_mask:0xf
    v_mul_f32_dpp v36, v19, v36 quad_perm:[0,0,2,2] row_mask:0xf bank_mask:0xf
    v_mul_f32_dpp v37, v19, v37 quad_perm:[1,1,3,3] row_mask:0xf bank_mask:0xf
    v_mul_f32_dpp v38, v19, v38 quad_perm:[0,0,2,2] row_mask:0xf bank_mask:0xf
    v_mul_f32_dpp v39, v19, v39 quad_perm:[1,1,3,3] row_mask:0xf bank_mask:0xf
    v_cndmask_b32 v40, 0, v24, s[64:65]
    v_cndmask_b32 v41, 0, v25, s[64:65]
    v_cndmask_b32 v42, 0, v24, s[66:67]
    v_cndmask_b32 v43, 0, v25, s[66:67]
    v_cndmask_b32 v44, 0, v24, s[68:69]
    v_cndmask_b32 v45, 0, v25, s[68:69]
    v_cndmask_b32 v46, 0, v24, s[70:71]
    v_cndmask_b32 v47, 0, v25, s[70:71]
    v_cndmask_b32 v48, 0, v24, s[72:73]
    v_cndmask_b32 v49, 0, v25, s[72:73]
    v_cndmask_b32 v50, 0, v24, s[74:75]
    v_cndmask_b32 v51, 0, v25, s[74:75]
    v_cndmask_b32 v52, 0, v24, s[76:77]
    v_cndmask_b32 v53, 0, v25, s[76:77]
    v_cndmask_b32 v54, 0, v24, s[78:79]
    v_cndmask_b32 v55, 0, v25, s[78:79]
    s_nop 1
L_dst0:
    v_mov_b32 v22, v18
    s_nop 1
    v_permlane32_swap_b32 v18, v22
    v_add_f32 v18, v18, v22
    v_mov_b32 v22, v18
    s_nop 1
    v_permlane16_swap_b32 v18, v22
    v_add_f32 v19, v18, v22
    v_mov_b32 v18, v17
    v_and_b32 v21, 1, v0
    v_lshlrev_b32 v21, 3, v21
    v_add_u32 v21, 148544, v21
    s_lshl_b32 s8, s3, 4
    s_sub_u32 s8, s8, 32
    v_add_u32 v22, s8, v21
    s_mov_b64 exec, 3
    ds_write_b64 v22, v[18:19]
    s_mov_b64 exec, -1
    s_waitcnt lgkmcnt(0)
    s_barrier
    ds_read2_b32 v[24:25], v21 offset0:0 offset1:4
    ds_read2_b32 v[26:27], v21 offset0:8 offset1:12
    ds_read2_b32 v[28:29], v21 offset0:16 offset1:20
    v_lshl_add_u32 v22, v0, 4, s101
    s_waitcnt lgkmcnt(0)
    v_max3_f32 v24, v24, v25, v26
    v_max3_f32 v27, v27, v28, v29
    v_max_f32 v24, v24, v27
    v_sub_f32 v19, v17, v24
    v_mul_f32 v19, s14, v19
    v_exp_f32 v19, v19
    s_waitcnt vmcnt(4)
    v_perm_b32 v56, v100, v96, s12
    v_perm_b32 v57, v108, v104, s12
    v_perm_b32 v58, v102, v98, s12
    v_perm_b32 v59, v110, v106, s12
    v_perm_b32 v60, v100, v96, s13
    v_perm_b32 v61, v108, v104, s13
    v_mfma_f32_16x16x16_bf16 v[32:35], v[40:41], v[56:57], v[32:35]
    v_perm_b32 v62, v102, v98, s13
    v_perm_b32 v63, v110, v106, s13
    v_mfma_f32_16x16x16_bf16 v[36:39], v[40:41], v[58:59], v[36:39]
    v_perm_b32 v56, v101, v97, s12
    v_perm_b32 v57, v109, v105, s12
    v_mfma_f32_16x16x16_bf16 v[32:35], v[44:45], v[60:61], v[32:35]
    v_perm_b32 v58, v103, v99, s12
    v_perm_b32 v59, v111, v107, s12
    v_mfma_f32_16x16x16_bf16 v[36:39], v[44:45], v[62:63], v[36:39]
    v_perm_b32 v60, v101, v97, s13
    v_perm_b32 v61, v109, v105, s13
    v_mfma_f32_16x16x16_bf16 v[32:35], v[48:49], v[56:57], v[32:35]
    v_perm_b32 v62, v103, v99, s13
    v_perm_b32 v63, v111, v107, s13
    v_mfma_f32_16x16x16_bf16 v[36:39], v[48:49], v[58:59], v[36:39]
    s_waitcnt vmcnt(0)
    v_perm_b32 v56, v116, v112, s12
    v_perm_b32 v57, v124, v120, s12
    v_mfma_f32_16x16x16_bf16 v[32:35], v[52:53], v[60:61], v[32:35]
    v_perm_b32 v58, v118, v114, s12
    v_perm_b32 v59, v126, v122, s12
    v_mfma_f32_16x16x16_bf16 v[36:39], v[52:53], v[62:63], v[36:39]
    v_perm_b32 v60, v116, v112, s13
    v_perm_b32 v61, v124, v120, s13
    v_mfma_f32_16x16x16_bf16 v[32:35], v[42:43], v[56:57], v[32:35]
    v_perm_b32 v62, v118, v114, s13
    v_perm_b32 v63, v126, v122, s13
    v_mfma_f32_16x16x16_bf16 v[36:39], v[42:43], v[58:59], v[36:39]
    v_perm_b32 v56, v117, v113, s12
    v_perm_b32 v57, v125, v121, s12
    v_mfma_f32_16x16x16_bf16 v[32:35], v[46:47], v[60:61], v[32:35]
    v_perm_b32 v58, v119, v115, s12
    v_perm_b32 v59, v127, v123, s12
    v_mfma_f32_16x16x16_bf16 v[36:39], v[46:47], v[62:63], v[36:39]
    v_perm_b32 v60, v117, v113, s13
    v_perm_b32 v61, v125, v121, s13
    v_mfma_f32_16x16x16_bf16 v[32:35], v[50:51], v[56:57], v[32:35]
    v_perm_b32 v62, v119, v115, s13
    v_perm_b32 v63, v127, v123, s13
    v_mfma_f32_16x16x16_bf16 v[36:39], v[50:51], v[58:59], v[36:39]
    v_mfma_f32_16x16x16_bf16 v[32:35], v[54:55], v[60:61], v[32:35]
    v_mfma_f32_16x16x16_bf16 v[36:39], v[54:55], v[62:63], v[36:39]
    s_nop 6
    s_branch L_tfin
L_drain1:
    s_waitcnt vmcnt(8)
    ds_read_b128 v[40:43], v13 offset:8192
    ds_read_b128 v[44:47], v14 offset:8192
    ds_read_b128 v[48:51], v15 offset:8192
    ds_read_b128 v[52:55], v16 offset:8192
    s_waitcnt lgkmcnt(3)
    v_mfma_f32_16x16x32_bf16 v[24:27], v[40:43], v[64:67], 0
    ds_read_b128 v[40:43], v13 offset:8448
    s_waitcnt lgkmcnt(3)
    v_mfma_f32_16x16x32_bf16 v[24:27], v[44:47], v[68:71], v[24:27]
    ds_read_b128 v[44:47], v14 offset:8448
    s_waitcnt lgkmcnt(3)
    v_mfma_f32_16x16x32_bf16 v[24:27], v[48:51], v[72:75], v[24:27]
    ds_read_b128 v[48:51], v15 offset:8448
    s_waitcnt lgkmcnt(3)
    v_mfma_f32_16x16x32_bf16 v[24:27], v[52:55], v[76:79], v[24:27]
    ds_read_b128 v[52:55], v16 offset:8448
    s_waitcnt lgkmcnt(3)
    v_mfma_f32_16x16x32_bf16 v[24:27], v[40:43], v[80:83], v[24:27]
    s_waitcnt lgkmcnt(2)
    v_mfma_f32_16x16x32_bf16 v[24:27], v[44:47], v[84:87], v[24:27]
    s_waitcnt lgkmcnt(1)
    v_mfma_f32_16x16x32_bf16 v[24:27], v[48:51], v[88:91], v[24:27]
    s_waitcnt lgkmcnt(0)
    v_mfma_f32_16x16x32_bf16 v[24:27], v[52:55], v[92:95], v[24:27]
    s_nop 7
    v_cvt_pk_bf16_f32 v28, 0, v24
    v_cvt_pk_bf16_f32 v29, 0, v25
    v_cvt_pk_bf16_f32 v30, 0, v26
    v_cvt_pk_bf16_f32 v31, 0, v27
    v_max3_f32 v21, v28, v29, v30
    v_max3_f32 v21, v21, v31, v17
    v_mov_b32 v22, v21
    s_nop 1
    v_permlane32_swap_b32 v21, v22
    v_max_f32 v21, v21, v22
    v_mov_b32 v22, v21
    s_nop 1
    v_permlane16_swap_b32 v21, v22
    v_max_f32 v21, v21, v22
    v_sub_f32 v19, v17, v21
    v_sub_f32 v28, v28, v21
    v_sub_f32 v29, v29, v21
    v_sub_f32 v30, v30, v21
    v_sub_f32 v31, v31, v21
    v_mul_f32 v19, s14, v19
    v_mul_f32 v28, s14, v28
    v_mul_f32 v29, s14, v29
    v_mul_f32 v30, s14, v30
    v_mul_f32 v31, s14, v31
    v_exp_f32 v19, v19
    v_exp_f32 v28, v28
    v_exp_f32 v29, v29
    v_exp_f32 v30, v30
    v_exp_f32 v31, v31
    v_mov_b32 v17, v21
    v_cvt_pk_bf16_f32 v24, v28, v29
    v_cvt_pk_bf16_f32 v25, v30, v31
    v_add_f32 v21, v28, v29
    v_add_f32 v22, v30, v31
    v_add_f32 v21, v21, v22
    v_fma_f32 v18, v18, v19, v21
    v_mul_f32_dpp v32, v19, v32 quad_perm:[0,0,2,2] row_mask:0xf bank_mask:0xf
    v_mul_f32_dpp v33, v19, v33 quad_perm:[1,1,3,3] row_mask:0xf bank_mask:0xf
    v_mul_f32_dpp v34, v19, v34 quad_perm:[0,0,2,2] row_mask:0xf bank_mask:0xf
    v_mul_f32_dpp v35, v19, v35 quad_perm:[1,1,3,3] row_mask:0xf bank_mask:0xf
    v_mul_f32_dpp v36, v19, v36 quad_perm:[0,0,2,2] row_mask:0xf bank_mask:0xf
    v_mul_f32_dpp v37, v19, v37 quad_perm:[1,1,3,3] row_mask:0xf bank_mask:0xf
    v_mul_f32_dpp v38, v19, v38 quad_perm:[0,0,2,2] row_mask:0xf bank_mask:0xf
    v_mul_f32_dpp v39, v19, v39 quad_perm:[1,1,3,3] row_mask:0xf bank_mask:0xf
    v_cndmask_b32 v40, 0, v24, s[64:65]
    v_cndmask_b32 v41, 0, v25, s[64:65]
    v_cndmask_b32 v42, 0, v24, s[66:67]
    v_cndmask_b32 v43, 0, v25, s[66:67]
    v_cndmask_b32 v44, 0, v24, s[68:69]
    v_cndmask_b32 v45, 0, v25, s[68:69]
    v_cndmask_b32 v46, 0, v24, s[70:71]
    v_cndmask_b32 v47, 0, v25, s[70:71]
    v_cndmask_b32 v48, 0, v24, s[72:73]
    v_cndmask_b32 v49, 0, v25, s[72:73]
    v_cndmask_b32 v50, 0, v24, s[74:75]
    v_cndmask_b32 v51, 0, v25, s[74:75]
    v_cndmask_b32 v52, 0, v24, s[76:77]
    v_cndmask_b32 v53, 0, v25, s[76:77]
    v_cndmask_b32 v54, 0, v24, s[78:79]
    v_cndmask_b32 v55, 0, v25, s[78:79]
    s_nop 1
L_dst1:
    v_mov_b32 v22, v18
    s_nop 1
    v_permlane32_swap_b32 v18, v22
    v_add_f32 v18, v18, v22
    v_mov_b32 v22, v18
    s_nop 1
    v_permlane16_swap_b32 v18, v22
    v_add_f32 v19, v18, v22
    v_mov_b32 v18, v17
    v_and_b32 v21, 1, v0
    v_lshlrev_b32 v21, 3, v21
    v_add_u32 v21, 148544, v21
    s_lshl_b32 s8, s3, 4
    s_sub_u32 s8, s8, 32
    v_add_u32 v22, s8, v21
    s_mov_b64 exec, 3
    ds_write_b64 v22, v[18:19]
    s_mov_b64 exec, -1
    s_waitcnt lgkmcnt(0)
    s_barrier
    ds_read2_b32 v[24:25], v21 offset0:0 offset1:4
    ds_read2_b32 v[26:27], v21 offset0:8 offset1:12
    ds_read2_b32 v[28:29], v21 offset0:16 offset1:20
    v_lshl_add_u32 v22, v0, 4, s101
    s_waitcnt lgkmcnt(0)
    v_max3_f32 v24, v24, v25, v26
    v_max3_f32 v27, v27, v28, v29
    v_max_f32 v24, v24, v27
    v_sub_f32 v19, v17, v24
    v_mul_f32 v19, s14, v19
    v_exp_f32 v19, v19
    s_cmp_ge_u32 s3, 6
    s_cbranch_scc1 L_tfin
    s_waitcnt vmcnt(4)
    v_perm_b32 v56, v132, v128, s12
    v_perm_b32 v57, v140, v136, s12
    v_perm_b32 v58, v134, v130, s12
    v_perm_b32 v59, v142, v138, s12
    v_perm_b32 v60, v132, v128, s13
    v_perm_b32 v61, v140, v136, s13
    v_mfma_f32_16x16x16_bf16 v[32:35], v[40:41], v[56:57], v[32:35]
    v_perm_b32 v62, v134, v130, s13
    v_perm_b32 v63, v142, v138, s13
    v_mfma_f32_16x16x16_bf16 v[36:39], v[40:41], v[58:59], v[36:39]
    v_perm_b32 v56, v133, v129, s12
    v_perm_b32 v57, v141, v137, s12
    v_mfma_f32_16x16x16_bf16 v[32:35], v[44:45], v[60:61], v[32:35]
    v_perm_b32 v58, v135, v131, s12
    v_perm_b32 v59, v143, v139, s12
    v_mfma_f32_16x16x16_bf16 v[36:39], v[44:45], v[62:63], v[36:39]
    v_perm_b32 v60, v133, v129, s13
    v_perm_b32 v61, v141, v137, s13
    v_mfma_f32_16x16x16_bf16 v[32:35], v[48:49], v[56:57], v[32:35]
    v_perm_b32 v62, v135, v131, s13
    v_perm_b32 v63, v143, v139, s13
    v_mfma_f32_16x16x16_bf16 v[36:39], v[48:49], v[58:59], v[36:39]
    s_waitcnt vmcnt(0)
    v_perm_b32 v56, v148, v144, s12
    v_perm_b32 v57, v156, v152, s12
    v_mfma_f32_16x16x16_bf16 v[32:35], v[52:53], v[60:61], v[32:35]
    v_perm_b32 v58, v150, v146, s12
    v_perm_b32 v59, v158, v154, s12
    v_mfma_f32_16x16x16_bf16 v[36:39], v[52:53], v[62:63], v[36:39]
    v_perm_b32 v60, v148, v144, s13
    v_perm_b32 v61, v156, v152, s13
    v_mfma_f32_16x16x16_bf16 v[32:35], v[42:43], v[56:57], v[32:35]
    v_perm_b32 v62, v150, v146, s13
    v_perm_b32 v63, v158, v154, s13
    v_mfma_f32_16x16x16_bf16 v[36:39], v[42:43], v[58:59], v[36:39]
    v_perm_b32 v56, v149, v145, s12
    v_perm_b32 v57, v157, v153, s12
    v_mfma_f32_16x16x16_bf16 v[32:35], v[46:47], v[60:61], v[32:35]
    v_perm_b32 v58, v151, v147, s12
    v_perm_b32 v59, v159, v155, s12
    v_mfma_f32_16x16x16_bf16 v[36:39], v[46:47], v[62:63], v[36:39]
    v_perm_b32 v60, v149, v145, s13
    v_perm_b32 v61, v157, v153, s13
    v_mfma_f32_16x16x16_bf16 v[32:35], v[50:51], v[56:57], v[32:35]
    v_perm_b32 v62, v151, v147, s13
    v_perm_b32 v63, v159, v155, s13
    v_mfma_f32_16x16x16_bf16 v[36:39], v[50:51], v[58:59], v[36:39]
    v_mfma_f32_16x16x16_bf16 v[32:35], v[54:55], v[60:61], v[32:35]
    v_mfma_f32_16x16x16_bf16 v[36:39], v[54:55], v[62:63], v[36:39]
    s_nop 7
L_tfin:
    v_mul_f32_dpp v32, v19, v32 quad_perm:[0,0,2,2] row_mask:0xf bank_mask:0xf
    v_mul_f32_dpp v33, v19, v33 quad_perm:[1,1,3,3] row_mask:0xf bank_mask:0xf
    v_mul_f32_dpp v34, v19, v34 quad_perm:[0,0,2,2] row_mask:0xf bank_mask:0xf
    v_mul_f32_dpp v35, v19, v35 quad_perm:[1,1,3,3] row_mask:0xf bank_mask:0xf
    ds_write_b128 v22, v[32:35] offset:0
    v_mul_f32_dpp v36, v19, v36 quad_perm:[0,0,2,2] row_mask:0xf bank_mask:0xf
    v_mul_f32_dpp v37, v19, v37 quad_perm:[1,1,3,3] row_mask:0xf bank_mask:0xf
    v_mul_f32_dpp v38, v19, v38 quad_perm:[0,0,2,2] row_mask:0xf bank_mask:0xf
    v_mul_f32_dpp v39, v19, v39 quad_perm:[1,1,3,3] row_mask:0xf bank_mask:0xf
    ds_write_b128 v22, v[36:39] offset:1024
    s_waitcnt lgkmcnt(0)
    s_barrier
    s_endpgm
L_reset:
    s_waitcnt lgkmcnt(0)
    s_mov_b32 s44, s42
    s_mov_b32 s45, s43
    s_mov_b32 s46, 1310720
    s_mov_b32 s47, 0x20000
    s_mov_b32 s48, s40
    s_mov_b32 s49, s41
    s_mov_b32 s50, 256
    s_mov_b32 s51, 0x20000
    v_mov_b32 v12, -1
    v_mov_b32 v13, -1
    v_mov_b32 v14, -1
    v_mov_b32 v15, -1
    v_lshlrev_b32 v11, 4, v0
    v_mov_b32 v16, 0
    s_mul_i32 s8, s3, 7168
    s_add_u32 s8, s8, 8192
    s_add_u32 s9, s8, 4096
    buffer_store_dwordx4 v[12:15], v11, s[44:47], s8 offen offset:0 sc1
    buffer_store_dwordx4 v[12:15], v11, s[44:47], s8 offen offset:1024 sc1
    buffer_store_dwordx4 v[12:15], v11, s[44:47], s8 offen offset:2048 sc1
    buffer_store_dwordx4 v[12:15], v11, s[44:47], s8 offen offset:3072 sc1
    buffer_store_dwordx4 v[12:15], v11, s[44:47], s9 offen offset:0 sc1
    buffer_store_dwordx4 v[12:15], v11, s[44:47], s9 offen offset:1024 sc1
    buffer_store_dwordx4 v[12:15], v11, s[44:47], s9 offen offset:2048 sc1
    s_lshl_b32 s8, s3, 12
    s_add_u32 s8, s8, 65536
    v_lshlrev_b32 v11, 8, v0
    v_and_b32 v16, 3, v0
    s_mov_b64 exec, 0xffff
    buffer_store_dword v16, v11, s[44:47], s8 offen sc1
    s_mov_b64 exec, -1
    s_waitcnt vmcnt(0)
    s_barrier
    s_cmp_lg_u32 s3, 0
    s_cbranch_scc1 L_st0
    v_mov_b32 v16, 1
    s_mov_b64 exec, 1
    buffer_store_dword v16, off, s[48:51], 0 sc1
    s_mov_b64 exec, -1
L_helper:
    s_waitcnt lgkmcnt(0)
    s_mov_b32 s44, s42
    s_mov_b32 s45, s43
    s_mov_b32 s46, 1310720
    s_mov_b32 s47, 0x20000
    s_mov_b32 s48, s40
    s_mov_b32 s49, s41
    s_mov_b32 s50, 256
    s_mov_b32 s51, 0x20000
    v_lshrrev_b32 v15, 5, v0
    v_lshlrev_b32 v15, 14, v15
    v_and_b32 v16, 31, v0
    v_lshl_add_u32 v250, v16, 4, v15
    s_lshl_b32 s9, s7, 16
    s_lshl_b32 s10, s3, 15
    s_add_u32 s9, s9, s10
    s_lshl_b32 s10, s6, 12
    s_add_u32 s9, s9, s10
    s_lshl_b32 s10, s5, 9
    s_add_u32 s9, s9, s10
    s_add_u32 s62, s9, 131072
    s_lshl_b32 s10, s7, 12
    s_lshl_b32 s11, s6, 10
    s_add_u32 s10, s10, s11
    s_lshl_b32 s11, s5, 7
    s_add_u32 s10, s10, s11
    s_add_u32 s63, s10, 1085440
    buffer_load_dwordx4 v[252:255], v250, s[44:47], s62 offen sc1
    s_cmp_eq_u32 s3, 1
    s_cbranch_scc1 L_h1
    v_mov_b32 v9, 148480
    v_mov_b32 v3, 0
    ds_write_b32 v9, v3
    s_waitcnt lgkmcnt(0)
L_h0a:
    s_barrier
    s_mov_b32 s15, 0
L_pf6:
    buffer_load_dword v3, off, s[48:51], 0 offset:0 sc1
    s_waitcnt vmcnt(0)
    v_readfirstlane_b32 s11, v3
    s_cmp_lg_u32 s11, 0
    s_nop 2
    s_cbranch_scc1 L_pf6_ok
    s_sleep 80
    s_add_u32 s15, s15, 1
    s_cmp_lt_u32 s15, 1000000
    s_cbranch_scc1 L_pf6
L_pf6_ok:
L_h0b:
    s_lshl_b32 s8, s4, 10
    s_add_u32 s8, s8, 32768
    v_lshlrev_b32 v11, 4, v0
    v_add_u32 v10, 147456, v11
    s_mov_b32 s15, 0
    buffer_load_dwordx4 v[12:15], v11, s[44:47], s8 offen sc1
L_pp7:
    buffer_load_dwordx4 v[16:19], v11, s[44:47], s8 offen sc1
    s_waitcnt vmcnt(1)
    v_max_u32 v3, v12, v13
    v_max3_u32 v3, v3, v14, v15
    v_cmp_eq_u32 vcc, -1, v3
    s_nop 0
    s_cbranch_vccz L_pp7_ok0
    buffer_load_dwordx4 v[12:15], v11, s[44:47], s8 offen sc1
    s_waitcnt vmcnt(1)
    v_max_u32 v3, v16, v17
    v_max3_u32 v3, v3, v18, v19
    v_cmp_eq_u32 vcc, -1, v3
    s_nop 0
    s_cbranch_vccz L_pp7_ok1
    s_add_u32 s15, s15, 1
    s_cmp_lt_u32 s15, 1000000
    s_cbranch_scc1 L_pp7
L_pp7_ok0:
    ds_write_b128 v10, v[12:15]
    s_branch L_pp7_end
L_pp7_ok1:
    ds_write_b128 v10, v[16:19]
L_pp7_end:
    v_mov_b32 v3, 1
    s_waitcnt lgkmcnt(0)
    ds_write_b32 v9, v3
    s_branch L_hm
L_h1:
    s_mov_b32 s100, s4
    s_cmp_eq_u32 s98, 0
    s_cbranch_scc1 L_mu
    s_barrier
    s_cmp_lg_u32 s98, 1
    s_cbranch_scc1 L_hm
    s_mov_b32 s15, 0
L_pf8:
    buffer_load_dword v3, off, s[48:51], 0 offset:0 sc1
    s_waitcnt vmcnt(0)
    v_readfirstlane_b32 s11, v3
    s_cmp_lg_u32 s11, 0
    s_nop 2
    s_cbranch_scc1 L_pf8_ok
    s_sleep 60
    s_add_u32 s15, s15, 1
    s_cmp_lt_u32 s15, 1000000
    s_cbranch_scc1 L_pf8
L_pf8_ok:
    s_add_u32 s100, s4, 14
L_mtask:
    s_mov_b32 s52, s36
    s_mov_b32 s53, s37
    s_mov_b32 s54, 2408448
    s_mov_b32 s55, 0x20000
    s_mov_b32 s56, s34
    s_mov_b32 s57, s35
    s_mov_b32 s58, 3584
    s_mov_b32 s59, 0x20000
    v_and_b32 v11, 1, v2
    v_lshl_add_u32 v11, v11, 2, v1
    v_lshlrev_b32 v11, 4, v11
    v_bfe_u32 v12, v2, 1, 2
    v_mul_u32_u24 v12, 896, v12
    v_lshrrev_b32 v13, 3, v2
    v_lshlrev_b32 v14, 7, v13
    v_add3_u32 v7, v11, v12, v14
    v_cmp_eq_u32 s[64:65], 0, v13
    v_cmp_eq_u32 s[66:67], 1, v13
    v_mov_b32 v12, 1073741824
    v_cndmask_b32 v8, v12, v7, s[64:65]
    v_lshl_add_u32 v11, v13, 2, v1
    v_mul_u32_u24 v11, 43008, v11
    v_and_b32 v12, 7, v2
    v_lshl_add_u32 v9, v12, 4, v11
    buffer_load_dwordx4 v[16:19], v7, s[56:59], 0 offen offset:0
    buffer_load_dwordx4 v[20:23], v7, s[56:59], 0 offen offset:256
    buffer_load_dwordx4 v[24:27], v7, s[56:59], 0 offen offset:512
    buffer_load_dwordx4 v[28:31], v8, s[56:59], 0 offen offset:768
    s_lshl_b32 s60, s100, 7
    buffer_load_dwordx4 v[64:67], v9, s[52:55], s60 offen nt
    s_add_u32 s60, s60, 5376
    buffer_load_dwordx4 v[68:71], v9, s[52:55], s60 offen nt
    s_add_u32 s60, s60, 5376
    buffer_load_dwordx4 v[72:75], v9, s[52:55], s60 offen nt
    s_add_u32 s60, s60, 5376
    buffer_load_dwordx4 v[76:79], v9, s[52:55], s60 offen nt
    s_add_u32 s60, s60, 5376
    buffer_load_dwordx4 v[80:83], v9, s[52:55], s60 offen nt
    s_add_u32 s60, s60, 5376
    buffer_load_dwordx4 v[84:87], v9, s[52:55], s60 offen nt
    s_add_u32 s60, s60, 5376
    buffer_load_dwordx4 v[88:91], v9, s[52:55], s60 offen nt
    s_add_u32 s60, s60, 5376
    buffer_load_dwordx4 v[92:95], v9, s[52:55], s60 offen nt
    s_add_u32 s60, s60, 306432
    buffer_load_dwordx4 v[96:99], v9, s[52:55], s60 offen nt
    s_add_u32 s60, s60, 5376
    buffer_load_dwordx4 v[100:103], v9, s[52:55], s60 offen nt
    s_add_u32 s60, s60, 5376
    buffer_load_dwordx4 v[104:107], v9, s[52:55], s60 offen nt
    s_add_u32 s60, s60, 5376
    buffer_load_dwordx4 v[108:111], v9, s[52:55], s60 offen nt
    s_add_u32 s60, s60, 5376
    buffer_load_dwordx4 v[112:115], v9, s[52:55], s60 offen nt
    s_add_u32 s60, s60, 5376
    buffer_load_dwordx4 v[116:119], v9, s[52:55], s60 offen nt
    s_add_u32 s60, s60, 5376
    buffer_load_dwordx4 v[120:123], v9, s[52:55], s60 offen nt
    s_add_u32 s60, s60, 5376
    buffer_load_dwordx4 v[124:127], v9, s[52:55], s60 offen nt
    s_add_u32 s60, s60, 306432
    buffer_load_dwordx4 v[128:131], v9, s[52:55], s60 offen nt
    s_add_u32 s60, s60, 5376
    buffer_load_dwordx4 v[132:135], v9, s[52:55], s60 offen nt
    s_add_u32 s60, s60, 5376
    buffer_load_dwordx4 v[136:139], v9, s[52:55], s60 offen nt
    s_add_u32 s60, s60, 5376
    buffer_load_dwordx4 v[140:143], v9, s[52:55], s60 offen nt
    s_add_u32 s60, s60, 5376
    buffer_load_dwordx4 v[144:147], v9, s[52:55], s60 offen nt
    s_add_u32 s60, s60, 5376
    buffer_load_dwordx4 v[148:151], v9, s[52:55], s60 offen nt
    s_add_u32 s60, s60, 5376
    buffer_load_dwordx4 v[152:155], v9, s[52:55], s60 offen nt
    s_add_u32 s60, s60, 5376
    buffer_load_dwordx4 v[156:159], v9, s[52:55], s60 offen nt
    s_add_u32 s60, s60, 306432
    buffer_load_dwordx4 v[160:163], v9, s[52:55], s60 offen nt
    s_add_u32 s60, s60, 5376
    buffer_load_dwordx4 v[164:167], v9, s[52:55], s60 offen nt
    s_add_u32 s60, s60, 5376
    buffer_load_dwordx4 v[168:171], v9, s[52:55], s60 offen nt
    s_add_u32 s60, s60, 5376
    buffer_load_dwordx4 v[172:175], v9, s[52:55], s60 offen nt
    s_add_u32 s60, s60, 5376
    buffer_load_dwordx4 v[176:179], v9, s[52:55], s60 offen nt
    s_add_u32 s60, s60, 5376
    buffer_load_dwordx4 v[180:183], v9, s[52:55], s60 offen nt
    s_add_u32 s60, s60, 5376
    buffer_load_dwordx4 v[184:187], v9, s[52:55], s60 offen nt
    s_add_u32 s60, s60, 5376
    buffer_load_dwordx4 v[188:191], v9, s[52:55], s60 offen nt
    s_add_u32 s60, s60, 306432
    s_waitcnt vmcnt(32)
    s_mov_b32 s8, 0xbfb8aa3b
    v_lshlrev_b32 v13, 16, v16
    v_and_b32 v14, 0xffff0000, v16
    v_mul_f32 v11, s8, v13
    v_mul_f32 v12, s8, v14
    v_exp_f32 v11, v11
    v_exp_f32 v12, v12
    v_add_f32 v11, 1.0, v11
    v_add_f32 v12, 1.0, v12
    v_rcp_f32 v11, v11
    v_rcp_f32 v12, v12
    v_mul_f32 v11, v13, v11
    v_mul_f32 v12, v14, v12
    v_cvt_pk_bf16_f32 v16, v11, v12
    v_lshlrev_b32 v13, 16, v17
    v_and_b32 v14, 0xffff0000, v17
    v_mul_f32 v11, s8, v13
    v_mul_f32 v12, s8, v14
    v_exp_f32 v11, v11
    v_exp_f32 v12, v12
    v_add_f32 v11, 1.0, v11
    v_add_f32 v12, 1.0, v12
    v_rcp_f32 v11, v11
    v_rcp_f32 v12, v12
    v_mul_f32 v11, v13, v11
    v_mul_f32 v12, v14, v12
    v_cvt_pk_bf16_f32 v17, v11, v12
    v_lshlrev_b32 v13, 16, v18
    v_and_b32 v14, 0xffff0000, v18
    v_mul_f32 v11, s8, v13
    v_mul_f32 v12, s8, v14
    v_exp_f32 v11, v11
    v_exp_f32 v12, v12
    v_add_f32 v11, 1.0, v11
    v_add_f32 v12, 1.0, v12
    v_rcp_f32 v11, v11
    v_rcp_f32 v12, v12
    v_mul_f32 v11, v13, v11
    v_mul_f32 v12, v14, v12
    v_cvt_pk_bf16_f32 v18, v11, v12
    v_lshlrev_b32 v13, 16, v19
    v_and_b32 v14, 0xffff0000, v19
    v_mul_f32 v11, s8, v13
    v_mul_f32 v12, s8, v14
    v_exp_f32 v11, v11
    v_exp_f32 v12, v12
    v_add_f32 v11, 1.0, v11
    v_add_f32 v12, 1.0, v12
    v_rcp_f32 v11, v11
    v_rcp_f32 v12, v12
    v_mul_f32 v11, v13, v11
    v_mul_f32 v12, v14, v12
    v_cvt_pk_bf16_f32 v19, v11, v12
    s_waitcnt vmcnt(24)
    v_perm_b32 v32, v68, v64, s12
    v_perm_b32 v33, v76, v72, s12
    v_perm_b32 v34, v84, v80, s12
    v_perm_b32 v35, v92, v88, s12
    v_perm_b32 v36, v68, v64, s13
    v_perm_b32 v37, v76, v72, s13
    v_perm_b32 v38, v84, v80, s13
    v_perm_b32 v39, v92, v88, s13
    v_perm_b32 v40, v69, v65, s12
    v_perm_b32 v41, v77, v73, s12
    v_perm_b32 v42, v85, v81, s12
    v_perm_b32 v43, v93, v89, s12
    v_perm_b32 v44, v69, v65, s13
    v_perm_b32 v45, v77, v73, s13
    v_perm_b32 v46, v85, v81, s13
    v_perm_b32 v47, v93, v89, s13
    v_perm_b32 v48, v70, v66, s12
    v_perm_b32 v49, v78, v74, s12
    v_perm_b32 v50, v86, v82, s12
    v_perm_b32 v51, v94, v90, s12
    v_perm_b32 v52, v70, v66, s13
    v_perm_b32 v53, v78, v74, s13
    v_perm_b32 v54, v86, v82, s13
    v_perm_b32 v55, v94, v90, s13
    v_perm_b32 v56, v71, v67, s12
    v_perm_b32 v57, v79, v75, s12
    v_perm_b32 v58, v87, v83, s12
    v_perm_b32 v59, v95, v91, s12
    v_perm_b32 v60, v71, v67, s13
    v_perm_b32 v61, v79, v75, s13
    v_perm_b32 v62, v87, v83, s13
    v_perm_b32 v63, v95, v91, s13
    buffer_load_dwordx4 v[64:67], v9, s[52:55], s60 offen nt
    s_add_u32 s60, s60, 5376
    buffer_load_dwordx4 v[68:71], v9, s[52:55], s60 offen nt
    s_add_u32 s60, s60, 5376
    buffer_load_dwordx4 v[72:75], v9, s[52:55], s60 offen nt
    s_add_u32 s60, s60, 5376
    buffer_load_dwordx4 v[76:79], v9, s[52:55], s60 offen nt
    s_add_u32 s60, s60, 5376
    buffer_load_dwordx4 v[80:83], v9, s[52:55], s60 offen nt
    s_add_u32 s60, s60, 5376
    buffer_load_dwordx4 v[84:87], v9, s[52:55], s60 offen nt
    s_add_u32 s60, s60, 5376
    buffer_load_dwordx4 v[88:91], v9, s[52:55], s60 offen nt
    s_add_u32 s60, s60, 5376
    buffer_load_dwordx4 v[92:95], v9, s[52:55], s60 offen nt
    s_add_u32 s60, s60, 306432
    v_cndmask_b32 v224, 0, v16, s[64:65]
    v_cndmask_b32 v225, 0, v17, s[64:65]
    v_cndmask_b32 v226, 0, v18, s[64:65]
    v_cndmask_b32 v227, 0, v19, s[64:65]
    s_nop 1
    v_mfma_f32_16x16x32_bf16 v[192:195], v[224:227], v[32:35], 0
    v_mfma_f32_16x16x32_bf16 v[196:199], v[224:227], v[36:39], 0
    v_mfma_f32_16x16x32_bf16 v[200:203], v[224:227], v[40:43], 0
    v_mfma_f32_16x16x32_bf16 v[204:207], v[224:227], v[44:47], 0
    v_mfma_f32_16x16x32_bf16 v[208:211], v[224:227], v[48:51], 0
    v_mfma_f32_16x16x32_bf16 v[212:215], v[224:227], v[52:55], 0
    v_mfma_f32_16x16x32_bf16 v[216:219], v[224:227], v[56:59], 0
    v_mfma_f32_16x16x32_bf16 v[220:223], v[224:227], v[60:63], 0
    v_lshlrev_b32 v13, 16, v20
    v_and_b32 v14, 0xffff0000, v20
    v_mul_f32 v11, s8, v13
    v_mul_f32 v12, s8, v14
    v_exp_f32 v11, v11
    v_exp_f32 v12, v12
    v_add_f32 v11, 1.0, v11
    v_add_f32 v12, 1.0, v12
    v_rcp_f32 v11, v11
    v_rcp_f32 v12, v12
    v_mul_f32 v11, v13, v11
    v_mul_f32 v12, v14, v12
    v_cvt_pk_bf16_f32 v20, v11, v12
    v_lshlrev_b32 v13, 16, v21
    v_and_b32 v14, 0xffff0000, v21
    v_mul_f32 v11, s8, v13
    v_mul_f32 v12, s8, v14
    v_exp_f32 v11, v11
    v_exp_f32 v12, v12
    v_add_f32 v11, 1.0, v11
    v_add_f32 v12, 1.0, v12
    v_rcp_f32 v11, v11
    v_rcp_f32 v12, v12
    v_mul_f32 v11, v13, v11
    v_mul_f32 v12, v14, v12
    v_cvt_pk_bf16_f32 v21, v11, v12
    v_lshlrev_b32 v13, 16, v22
    v_and_b32 v14, 0xffff0000, v22
    v_mul_f32 v11, s8, v13
    v_mul_f32 v12, s8, v14
    v_exp_f32 v11, v11
    v_exp_f32 v12, v12
    v_add_f32 v11, 1.0, v11
    v_add_f32 v12, 1.0, v12
    v_rcp_f32 v11, v11
    v_rcp_f32 v12, v12
    v_mul_f32 v11, v13, v11
    v_mul_f32 v12, v14, v12
    v_cvt_pk_bf16_f32 v22, v11, v12
    v_lshlrev_b32 v13, 16, v23
    v_and_b32 v14, 0xffff0000, v23
    v_mul_f32 v11, s8, v13
    v_mul_f32 v12, s8, v14
    v_exp_f32 v11, v11
    v_exp_f32 v12, v12
    v_add_f32 v11, 1.0, v11
    v_add_f32 v12, 1.0, v12
    v_rcp_f32 v11, v11
    v_rcp_f32 v12, v12
    v_mul_f32 v11, v13, v11
    v_mul_f32 v12, v14, v12
    v_cvt_pk_bf16_f32 v23, v11, v12
    s_waitcnt vmcnt(24)
    v_perm_b32 v32, v100, v96, s12
    v_perm_b32 v33, v108, v104, s12
    v_perm_b32 v34, v116, v112, s12
    v_perm_b32 v35, v124, v120, s12
    v_perm_b32 v36, v100, v96, s13
    v_perm_b32 v37, v108, v104, s13
    v_perm_b32 v38, v116, v112, s13
    v_perm_b32 v39, v124, v120, s13
    v_perm_b32 v40, v101, v97, s12
    v_perm_b32 v41, v109, v105, s12
    v_perm_b32 v42, v117, v113, s12
    v_perm_b32 v43, v125, v121, s12
    v_perm_b32 v44, v101, v97, s13
    v_perm_b32 v45, v109, v105, s13
    v_perm_b32 v46, v117, v113, s13
    v_perm_b32 v47, v125, v121, s13
    v_perm_b32 v48, v102, v98, s12
    v_perm_b32 v49, v110, v106, s12
    v_perm_b32 v50, v118, v114, s12
    v_perm_b32 v51, v126, v122, s12
    v_perm_b32 v52, v102, v98, s13
    v_perm_b32 v53, v110, v106, s13
    v_perm_b32 v54, v118, v114, s13
    v_perm_b32 v55, v126, v122, s13
    v_perm_b32 v56, v103, v99, s12
    v_perm_b32 v57, v111, v107, s12
    v_perm_b32 v58, v119, v115, s12
    v_perm_b32 v59, v127, v123, s12
    v_perm_b32 v60, v103, v99, s13
    v_perm_b32 v61, v111, v107, s13
    v_perm_b32 v62, v119, v115, s13
    v_perm_b32 v63, v127, v123, s13
    buffer_load_dwordx4 v[96:99], v9, s[52:55], s60 offen nt
    s_add_u32 s60, s60, 5376
    buffer_load_dwordx4 v[100:103], v9, s[52:55], s60 offen nt
    s_add_u32 s60, s60, 5376
    buffer_load_dwordx4 v[104:107], v9, s[52:55], s60 offen nt
    s_add_u32 s60, s60, 5376
    buffer_load_dwordx4 v[108:111], v9, s[52:55], s60 offen nt
    s_add_u32 s60, s60, 5376
    buffer_load_dwordx4 v[112:115], v9, s[52:55], s60 offen nt
    s_add_u32 s60, s60, 5376
    buffer_load_dwordx4 v[116:119], v9, s[52:55], s60 offen nt
    s_add_u32 s60, s60, 5376
    buffer_load_dwordx4 v[120:123], v9, s[52:55], s60 offen nt
    s_add_u32 s60, s60, 5376
    buffer_load_dwordx4 v[124:127], v9, s[52:55], s60 offen nt
    s_add_u32 s60, s60, 306432
    v_cndmask_b32 v224, 0, v16, s[66:67]
    v_cndmask_b32 v225, 0, v17, s[66:67]
    v_cndmask_b32 v226, 0, v18, s[66:67]
    v_cndmask_b32 v227, 0, v19, s[66:67]
    s_nop 1
    v_mfma_f32_16x16x32_bf16 v[192:195], v[224:227], v[32:35], v[192:195]
    v_mfma_f32_16x16x32_bf16 v[196:199], v[224:227], v[36:39], v[196:199]
    v_mfma_f32_16x16x32_bf16 v[200:203], v[224:227], v[40:43], v[200:203]
    v_mfma_f32_16x16x32_bf16 v[204:207], v[224:227], v[44:47], v[204:207]
    v_mfma_f32_16x16x32_bf16 v[208:211], v[224:227], v[48:51], v[208:211]
    v_mfma_f32_16x16x32_bf16 v[212:215], v[224:227], v[52:55], v[212:215]
    v_mfma_f32_16x16x32_bf16 v[216:219], v[224:227], v[56:59], v[216:219]
    v_mfma_f32_16x16x32_bf16 v[220:223], v[224:227], v[60:63], v[220:223]
    v_lshlrev_b32 v13, 16, v24
    v_and_b32 v14, 0xffff0000, v24
    v_mul_f32 v11, s8, v13
    v_mul_f32 v12, s8, v14
    v_exp_f32 v11, v11
    v_exp_f32 v12, v12
    v_add_f32 v11, 1.0, v11
    v_add_f32 v12, 1.0, v12
    v_rcp_f32 v11, v11
    v_rcp_f32 v12, v12
    v_mul_f32 v11, v13, v11
    v_mul_f32 v12, v14, v12
    v_cvt_pk_bf16_f32 v24, v11, v12
    v_lshlrev_b32 v13, 16, v25
    v_and_b32 v14, 0xffff0000, v25
    v_mul_f32 v11, s8, v13
    v_mul_f32 v12, s8, v14
    v_exp_f32 v11, v11
    v_exp_f32 v12, v12
    v_add_f32 v11, 1.0, v11
    v_add_f32 v12, 1.0, v12
    v_rcp_f32 v11, v11
    v_rcp_f32 v12, v12
    v_mul_f32 v11, v13, v11
    v_mul_f32 v12, v14, v12
    v_cvt_pk_bf16_f32 v25, v11, v12
    v_lshlrev_b32 v13, 16, v26
    v_and_b32 v14, 0xffff0000, v26
    v_mul_f32 v11, s8, v13
    v_mul_f32 v12, s8, v14
    v_exp_f32 v11, v11
    v_exp_f32 v12, v12
    v_add_f32 v11, 1.0, v11
    v_add_f32 v12, 1.0, v12
    v_rcp_f32 v11, v11
    v_rcp_f32 v12, v12
    v_mul_f32 v11, v13, v11
    v_mul_f32 v12, v14, v12
    v_cvt_pk_bf16_f32 v26, v11, v12
    v_lshlrev_b32 v13, 16, v27
    v_and_b32 v14, 0xffff0000, v27
    v_mul_f32 v11, s8, v13
    v_mul_f32 v12, s8, v14
    v_exp_f32 v11, v11
    v_exp_f32 v12, v12
    v_add_f32 v11, 1.0, v11
    v_add_f32 v12, 1.0, v12
    v_rcp_f32 v11, v11
    v_rcp_f32 v12, v12
    v_mul_f32 v11, v13, v11
    v_mul_f32 v12, v14, v12
    v_cvt_pk_bf16_f32 v27, v11, v12
    s_waitcnt vmcnt(24)
    v_perm_b32 v32, v132, v128, s12
    v_perm_b32 v33, v140, v136, s12
    v_perm_b32 v34, v148, v144, s12
    v_perm_b32 v35, v156, v152, s12
    v_perm_b32 v36, v132, v128, s13
    v_perm_b32 v37, v140, v136, s13
    v_perm_b32 v38, v148, v144, s13
    v_perm_b32 v39, v156, v152, s13
    v_perm_b32 v40, v133, v129, s12
    v_perm_b32 v41, v141, v137, s12
    v_perm_b32 v42, v149, v145, s12
    v_perm_b32 v43, v157, v153, s12
    v_perm_b32 v44, v133, v129, s13
    v_perm_b32 v45, v141, v137, s13
    v_perm_b32 v46, v149, v145, s13
    v_perm_b32 v47, v157, v153, s13
    v_perm_b32 v48, v134, v130, s12
    v_perm_b32 v49, v142, v138, s12
    v_perm_b32 v50, v150, v146, s12
    v_perm_b32 v51, v158, v154, s12
    v_perm_b32 v52, v134, v130, s13
    v_perm_b32 v53, v142, v138, s13
    v_perm_b32 v54, v150, v146, s13
    v_perm_b32 v55, v158, v154, s13
    v_perm_b32 v56, v135, v131, s12
    v_perm_b32 v57, v143, v139, s12
    v_perm_b32 v58, v151, v147, s12
    v_perm_b32 v59, v159, v155, s12
    v_perm_b32 v60, v135, v131, s13
    v_perm_b32 v61, v143, v139, s13
    v_perm_b32 v62, v151, v147, s13
    v_perm_b32 v63, v159, v155, s13
    buffer_load_dwordx4 v[128:131], v9, s[52:55], s60 offen nt
    s_add_u32 s60, s60, 5376
    buffer_load_dwordx4 v[132:135], v9, s[52:55], s60 offen nt
    s_add_u32 s60, s60, 5376
    buffer_load_dwordx4 v[136:139], v9, s[52:55], s60 offen nt
    s_add_u32 s60, s60, 5376
    buffer_load_dwordx4 v[140:143], v9, s[52:55], s60 offen nt
    s_add_u32 s60, s60, 5376
    buffer_load_dwordx4 v[144:147], v9, s[52:55], s60 offen nt
    s_add_u32 s60, s60, 5376
    buffer_load_dwordx4 v[148:151], v9, s[52:55], s60 offen nt
    s_add_u32 s60, s60, 5376
    buffer_load_dwordx4 v[152:155], v9, s[52:55], s60 offen nt
    s_add_u32 s60, s60, 5376
    buffer_load_dwordx4 v[156:159], v9, s[52:55], s60 offen nt
    s_add_u32 s60, s60, 306432
    v_cndmask_b32 v224, 0, v20, s[64:65]
    v_cndmask_b32 v225, 0, v21, s[64:65]
    v_cndmask_b32 v226, 0, v22, s[64:65]
    v_cndmask_b32 v227, 0, v23, s[64:65]
    s_nop 1
    v_mfma_f32_16x16x32_bf16 v[192:195], v[224:227], v[32:35], v[192:195]
    v_mfma_f32_16x16x32_bf16 v[196:199], v[224:227], v[36:39], v[196:199]
    v_mfma_f32_16x16x32_bf16 v[200:203], v[224:227], v[40:43], v[200:203]
    v_mfma_f32_16x16x32_bf16 v[204:207], v[224:227], v[44:47], v[204:207]
    v_mfma_f32_16x16x32_bf16 v[208:211], v[224:227], v[48:51], v[208:211]
    v_mfma_f32_16x16x32_bf16 v[212:215], v[224:227], v[52:55], v[212:215]
    v_mfma_f32_16x16x32_bf16 v[216:219], v[224:227], v[56:59], v[216:219]
    v_mfma_f32_16x16x32_bf16 v[220:223], v[224:227], v[60:63], v[220:223]
    v_lshlrev_b32 v13, 16, v28
    v_and_b32 v14, 0xffff0000, v28
    v_mul_f32 v11, s8, v13
    v_mul_f32 v12, s8, v14
    v_exp_f32 v11, v11
    v_exp_f32 v12, v12
    v_add_f32 v11, 1.0, v11
    v_add_f32 v12, 1.0, v12
    v_rcp_f32 v11, v11
    v_rcp_f32 v12, v12
    v_mul_f32 v11, v13, v11
    v_mul_f32 v12, v14, v12
    v_cvt_pk_bf16_f32 v28, v11, v12
    v_lshlrev_b32 v13, 16, v29
    v_and_b32 v14, 0xffff0000, v29
    v_mul_f32 v11, s8, v13
    v_mul_f32 v12, s8, v14
    v_exp_f32 v11, v11
    v_exp_f32 v12, v12
    v_add_f32 v11, 1.0, v11
    v_add_f32 v12, 1.0, v12
    v_rcp_f32 v11, v11
    v_rcp_f32 v12, v12
    v_mul_f32 v11, v13, v11
    v_mul_f32 v12, v14, v12
    v_cvt_pk_bf16_f32 v29, v11, v12
    v_lshlrev_b32 v13, 16, v30
    v_and_b32 v14, 0xffff0000, v30
    v_mul_f32 v11, s8, v13
    v_mul_f32 v12, s8, v14
    v_exp_f32 v11, v11
    v_exp_f32 v12, v12
    v_add_f32 v11, 1.0, v11
    v_add_f32 v12, 1.0, v12
    v_rcp_f32 v11, v11
    v_rcp_f32 v12, v12
    v_mul_f32 v11, v13, v11
    v_mul_f32 v12, v14, v12
    v_cvt_pk_bf16_f32 v30, v11, v12
    v_lshlrev_b32 v13, 16, v31
    v_and_b32 v14, 0xffff0000, v31
    v_mul_f32 v11, s8, v13
    v_mul_f32 v12, s8, v14
    v_exp_f32 v11, v11
    v_exp_f32 v12, v12
    v_add_f32 v11, 1.0, v11
    v_add_f32 v12, 1.0, v12
    v_rcp_f32 v11, v11
    v_rcp_f32 v12, v12
    v_mul_f32 v11, v13, v11
    v_mul_f32 v12, v14, v12
    v_cvt_pk_bf16_f32 v31, v11, v12
    s_waitcnt vmcnt(24)
    v_perm_b32 v32, v164, v160, s12
    v_perm_b32 v33, v172, v168, s12
    v_perm_b32 v34, v180, v176, s12
    v_perm_b32 v35, v188, v184, s12
    v_perm_b32 v36, v164, v160, s13
    v_perm_b32 v37, v172, v168, s13
    v_perm_b32 v38, v180, v176, s13
    v_perm_b32 v39, v188, v184, s13
    v_perm_b32 v40, v165, v161, s12
    v_perm_b32 v41, v173, v169, s12
    v_perm_b32 v42, v181, v177, s12
    v_perm_b32 v43, v189, v185, s12
    v_perm_b32 v44, v165, v161, s13
    v_perm_b32 v45, v173, v169, s13
    v_perm_b32 v46, v181, v177, s13
    v_perm_b32 v47, v189, v185, s13
    v_perm_b32 v48, v166, v162, s12
    v_perm_b32 v49, v174, v170, s12
    v_perm_b32 v50, v182, v178, s12
    v_perm_b32 v51, v190, v186, s12
    v_perm_b32 v52, v166, v162, s13
    v_perm_b32 v53, v174, v170, s13
    v_perm_b32 v54, v182, v178, s13
    v_perm_b32 v55, v190, v186, s13
    v_perm_b32 v56, v167, v163, s12
    v_perm_b32 v57, v175, v171, s12
    v_perm_b32 v58, v183, v179, s12
    v_perm_b32 v59, v191, v187, s12
    v_perm_b32 v60, v167, v163, s13
    v_perm_b32 v61, v175, v171, s13
    v_perm_b32 v62, v183, v179, s13
    v_perm_b32 v63, v191, v187, s13
    v_cndmask_b32 v224, 0, v20, s[66:67]
    v_cndmask_b32 v225, 0, v21, s[66:67]
    v_cndmask_b32 v226, 0, v22, s[66:67]
    v_cndmask_b32 v227, 0, v23, s[66:67]
    s_nop 1
    v_mfma_f32_16x16x32_bf16 v[192:195], v[224:227], v[32:35], v[192:195]
    v_mfma_f32_16x16x32_bf16 v[196:199], v[224:227], v[36:39], v[196:199]
    v_mfma_f32_16x16x32_bf16 v[200:203], v[224:227], v[40:43], v[200:203]
    v_mfma_f32_16x16x32_bf16 v[204:207], v[224:227], v[44:47], v[204:207]
    v_mfma_f32_16x16x32_bf16 v[208:211], v[224:227], v[48:51], v[208:211]
    v_mfma_f32_16x16x32_bf16 v[212:215], v[224:227], v[52:55], v[212:215]
    v_mfma_f32_16x16x32_bf16 v[216:219], v[224:227], v[56:59], v[216:219]
    v_mfma_f32_16x16x32_bf16 v[220:223], v[224:227], v[60:63], v[220:223]
    s_waitcnt vmcnt(16)
    v_perm_b32 v32, v68, v64, s12
    v_perm_b32 v33, v76, v72, s12
    v_perm_b32 v34, v84, v80, s12
    v_perm_b32 v35, v92, v88, s12
    v_perm_b32 v36, v68, v64, s13
    v_perm_b32 v37, v76, v72, s13
    v_perm_b32 v38, v84, v80, s13
    v_perm_b32 v39, v92, v88, s13
    v_perm_b32 v40, v69, v65, s12
    v_perm_b32 v41, v77, v73, s12
    v_perm_b32 v42, v85, v81, s12
    v_perm_b32 v43, v93, v89, s12
    v_perm_b32 v44, v69, v65, s13
    v_perm_b32 v45, v77, v73, s13
    v_perm_b32 v46, v85, v81, s13
    v_perm_b32 v47, v93, v89, s13
    v_perm_b32 v48, v70, v66, s12
    v_perm_b32 v49, v78, v74, s12
    v_perm_b32 v50, v86, v82, s12
    v_perm_b32 v51, v94, v90, s12
    v_perm_b32 v52, v70, v66, s13
    v_perm_b32 v53, v78, v74, s13
    v_perm_b32 v54, v86, v82, s13
    v_perm_b32 v55, v94, v90, s13
    v_perm_b32 v56, v71, v67, s12
    v_perm_b32 v57, v79, v75, s12
    v_perm_b32 v58, v87, v83, s12
    v_perm_b32 v59, v95, v91, s12
    v_perm_b32 v60, v71, v67, s13
    v_perm_b32 v61, v79, v75, s13
    v_perm_b32 v62, v87, v83, s13
    v_perm_b32 v63, v95, v91, s13
    v_cndmask_b32 v224, 0, v24, s[64:65]
    v_cndmask_b32 v225, 0, v25, s[64:65]
    v_cndmask_b32 v226, 0, v26, s[64:65]
    v_cndmask_b32 v227, 0, v27, s[64:65]
    s_nop 1
    v_mfma_f32_16x16x32_bf16 v[192:195], v[224:227], v[32:35], v[192:195]
    v_mfma_f32_16x16x32_bf16 v[196:199], v[224:227], v[36:39], v[196:199]
    v_mfma_f32_16x16x32_bf16 v[200:203], v[224:227], v[40:43], v[200:203]
    v_mfma_f32_16x16x32_bf16 v[204:207], v[224:227], v[44:47], v[204:207]
    v_mfma_f32_16x16x32_bf16 v[208:211], v[224:227], v[48:51], v[208:211]
    v_mfma_f32_16x16x32_bf16 v[212:215], v[224:227], v[52:55], v[212:215]
    v_mfma_f32_16x16x32_bf16 v[216:219], v[224:227], v[56:59], v[216:219]
    v_mfma_f32_16x16x32_bf16 v[220:223], v[224:227], v[60:63], v[220:223]
    s_waitcnt vmcnt(8)
    v_perm_b32 v32, v100, v96, s12
    v_perm_b32 v33, v108, v104, s12
    v_perm_b32 v34, v116, v112, s12
    v_perm_b32 v35, v124, v120, s12
    v_perm_b32 v36, v100, v96, s13
    v_perm_b32 v37, v108, v104, s13
    v_perm_b32 v38, v116, v112, s13
    v_perm_b32 v39, v124, v120, s13
    v_perm_b32 v40, v101, v97, s12
    v_perm_b32 v41, v109, v105, s12
    v_perm_b32 v42, v117, v113, s12
    v_perm_b32 v43, v125, v121, s12
    v_perm_b32 v44, v101, v97, s13
    v_perm_b32 v45, v109, v105, s13
    v_perm_b32 v46, v117, v113, s13
    v_perm_b32 v47, v125, v121, s13
    v_perm_b32 v48, v102, v98, s12
    v_perm_b32 v49, v110, v106, s12
    v_perm_b32 v50, v118, v114, s12
    v_perm_b32 v51, v126, v122, s12
    v_perm_b32 v52, v102, v98, s13
    v_perm_b32 v53, v110, v106, s13
    v_perm_b32 v54, v118, v114, s13
    v_perm_b32 v55, v126, v122, s13
    v_perm_b32 v56, v103, v99, s12
    v_perm_b32 v57, v111, v107, s12
    v_perm_b32 v58, v119, v115, s12
    v_perm_b32 v59, v127, v123, s12
    v_perm_b32 v60, v103, v99, s13
    v_perm_b32 v61, v111, v107, s13
    v_perm_b32 v62, v119, v115, s13
    v_perm_b32 v63, v127, v123, s13
    v_cndmask_b32 v224, 0, v24, s[66:67]
    v_cndmask_b32 v225, 0, v25, s[66:67]
    v_cndmask_b32 v226, 0, v26, s[66:67]
    v_cndmask_b32 v227, 0, v27, s[66:67]
    s_nop 1
    v_mfma_f32_16x16x32_bf16 v[192:195], v[224:227], v[32:35], v[192:195]
    v_mfma_f32_16x16x32_bf16 v[196:199], v[224:227], v[36:39], v[196:199]
    v_mfma_f32_16x16x32_bf16 v[200:203], v[224:227], v[40:43], v[200:203]
    v_mfma_f32_16x16x32_bf16 v[204:207], v[224:227], v[44:47], v[204:207]
    v_mfma_f32_16x16x32_bf16 v[208:211], v[224:227], v[48:51], v[208:211]
    v_mfma_f32_16x16x32_bf16 v[212:215], v[224:227], v[52:55], v[212:215]
    v_mfma_f32_16x16x32_bf16 v[216:219], v[224:227], v[56:59], v[216:219]
    v_mfma_f32_16x16x32_bf16 v[220:223], v[224:227], v[60:63], v[220:223]
    s_waitcnt vmcnt(0)
    v_perm_b32 v32, v132, v128, s12
    v_perm_b32 v33, v140, v136, s12
    v_perm_b32 v34, v148, v144, s12
    v_perm_b32 v35, v156, v152, s12
    v_perm_b32 v36, v132, v128, s13
    v_perm_b32 v37, v140, v136, s13
    v_perm_b32 v38, v148, v144, s13
    v_perm_b32 v39, v156, v152, s13
    v_perm_b32 v40, v133, v129, s12
    v_perm_b32 v41, v141, v137, s12
    v_perm_b32 v42, v149, v145, s12
    v_perm_b32 v43, v157, v153, s12
    v_perm_b32 v44, v133, v129, s13
    v_perm_b32 v45, v141, v137, s13
    v_perm_b32 v46, v149, v145, s13
    v_perm_b32 v47, v157, v153, s13
    v_perm_b32 v48, v134, v130, s12
    v_perm_b32 v49, v142, v138, s12
    v_perm_b32 v50, v150, v146, s12
    v_perm_b32 v51, v158, v154, s12
    v_perm_b32 v52, v134, v130, s13
    v_perm_b32 v53, v142, v138, s13
    v_perm_b32 v54, v150, v146, s13
    v_perm_b32 v55, v158, v154, s13
    v_perm_b32 v56, v135, v131, s12
    v_perm_b32 v57, v143, v139, s12
    v_perm_b32 v58, v151, v147, s12
    v_perm_b32 v59, v159, v155, s12
    v_perm_b32 v60, v135, v131, s13
    v_perm_b32 v61, v143, v139, s13
    v_perm_b32 v62, v151, v147, s13
    v_perm_b32 v63, v159, v155, s13
    v_cndmask_b32 v224, 0, v28, s[64:65]
    v_cndmask_b32 v225, 0, v29, s[64:65]
    v_cndmask_b32 v226, 0, v30, s[64:65]
    v_cndmask_b32 v227, 0, v31, s[64:65]
    s_nop 1
    v_mfma_f32_16x16x32_bf16 v[192:195], v[224:227], v[32:35], v[192:195]
    v_mfma_f32_16x16x32_bf16 v[196:199], v[224:227], v[36:39], v[196:199]
    v_mfma_f32_16x16x32_bf16 v[200:203], v[224:227], v[40:43], v[200:203]
    v_mfma_f32_16x16x32_bf16 v[204:207], v[224:227], v[44:47], v[204:207]
    v_mfma_f32_16x16x32_bf16 v[208:211], v[224:227], v[48:51], v[208:211]
    v_mfma_f32_16x16x32_bf16 v[212:215], v[224:227], v[52:55], v[212:215]
    v_mfma_f32_16x16x32_bf16 v[216:219], v[224:227], v[56:59], v[216:219]
    v_mfma_f32_16x16x32_bf16 v[220:223], v[224:227], v[60:63], v[220:223]
    v_and_b32 v11, 1, v1
    v_lshrrev_b32 v12, 1, v1
    v_lshl_add_u32 v11, v11, 1, v12
    v_mul_u32_u24 v11, 5376, v11
    v_lshl_add_u32 v11, v2, 4, v11
    v_mov_b32 v12, 1073741824
    v_cndmask_b32 v11, v12, v11, s[64:65]
    v_add_f32_dpp v192, v193, v192 row_ror:8 row_mask:0xf bank_mask:0xf
    v_add_f32_dpp v196, v197, v196 row_ror:8 row_mask:0xf bank_mask:0xf
    v_add_f32_dpp v200, v201, v200 row_ror:8 row_mask:0xf bank_mask:0xf
    v_add_f32_dpp v204, v205, v204 row_ror:8 row_mask:0xf bank_mask:0xf
    v_add_f32_dpp v208, v209, v208 row_ror:8 row_mask:0xf bank_mask:0xf
    v_add_f32_dpp v212, v213, v212 row_ror:8 row_mask:0xf bank_mask:0xf
    v_add_f32_dpp v216, v217, v216 row_ror:8 row_mask:0xf bank_mask:0xf
    v_add_f32_dpp v220, v221, v220 row_ror:8 row_mask:0xf bank_mask:0xf
    v_add_f32_dpp v194, v195, v194 row_ror:8 row_mask:0xf bank_mask:0xf
    v_add_f32_dpp v198, v199, v198 row_ror:8 row_mask:0xf bank_mask:0xf
    v_add_f32_dpp v202, v203, v202 row_ror:8 row_mask:0xf bank_mask:0xf
    v_add_f32_dpp v206, v207, v206 row_ror:8 row_mask:0xf bank_mask:0xf
    v_add_f32_dpp v210, v211, v210 row_ror:8 row_mask:0xf bank_mask:0xf
    v_add_f32_dpp v214, v215, v214 row_ror:8 row_mask:0xf bank_mask:0xf
    v_add_f32_dpp v218, v219, v218 row_ror:8 row_mask:0xf bank_mask:0xf
    v_add_f32_dpp v222, v223, v222 row_ror:8 row_mask:0xf bank_mask:0xf
    v_permlane32_swap_b32 v192, v194
    v_permlane32_swap_b32 v196, v198
    v_permlane32_swap_b32 v200, v202
    v_permlane32_swap_b32 v204, v206
    v_permlane32_swap_b32 v208, v210
    v_permlane32_swap_b32 v212, v214
    v_permlane32_swap_b32 v216, v218
    v_permlane32_swap_b32 v220, v222
    v_add_f32 v192, v192, v194
    v_add_f32 v196, v196, v198
    v_add_f32 v200, v200, v202
    v_add_f32 v204, v204, v206
    v_add_f32 v208, v208, v210
    v_add_f32 v212, v212, v214
    v_add_f32 v216, v216, v218
    v_add_f32 v220, v220, v222
    v_cvt_pk_bf16_f32 v192, 0, v192
    v_cvt_pk_bf16_f32 v196, 0, v196
    v_cvt_pk_bf16_f32 v200, 0, v200
    v_cvt_pk_bf16_f32 v204, 0, v204
    v_cvt_pk_bf16_f32 v208, 0, v208
    v_cvt_pk_bf16_f32 v212, 0, v212
    v_cvt_pk_bf16_f32 v216, 0, v216
    v_cvt_pk_bf16_f32 v220, 0, v220
    s_mov_b32 s8, 0
    s_sub_u32 s9, s100, 7
    s_cmp_lt_u32 s9, 7
    s_cselect_b32 s8, 1.0, s8
    s_sub_u32 s9, s100, 28
    s_cmp_lt_u32 s9, 7
    s_cselect_b32 s8, 1.0, s8
    v_add_f32 v192, s8, v192
    v_add_f32 v196, s8, v196
    v_add_f32 v200, s8, v200
    v_add_f32 v204, s8, v204
    v_add_f32 v208, s8, v208
    v_add_f32 v212, s8, v212
    v_add_f32 v216, s8, v216
    v_add_f32 v220, s8, v220
    v_cvt_pk_bf16_f32 v12, v192, v196
    v_min_u32 v12, -2, v12
    v_cvt_pk_bf16_f32 v13, v200, v204
    v_min_u32 v13, -2, v13
    v_cvt_pk_bf16_f32 v14, v208, v212
    v_min_u32 v14, -2, v14
    v_cvt_pk_bf16_f32 v15, v216, v220
    v_min_u32 v15, -2, v15
    s_lshl_b32 s8, s100, 7
    s_add_u32 s8, s8, 8192
    buffer_store_dwordx4 v[12:15], v11, s[44:47], s8 offen sc1
    s_nop 0
    s_branch L_hm
L_mu:
    s_mov_b32 s52, s36
    s_mov_b32 s53, s37
    s_mov_b32 s54, 2408448
    s_mov_b32 s55, 0x20000
    s_mov_b32 s56, s34
    s_mov_b32 s57, s35
    s_mov_b32 s58, 3584
    s_mov_b32 s59, 0x20000
    v_lshrrev_b32 v5, 2, v2
    v_and_b32 v6, 3, v0
    v_lshl_add_u32 v11, v6, 2, v1
    v_lshlrev_b32 v11, 4, v11
    v_mov_b32 v12, 896
    v_mad_u32_u24 v7, v5, v12, v11
    v_cmp_gt_u32 vcc, 2, v6
    v_mov_b32 v12, 1073741824
    s_nop 0
    v_cndmask_b32 v8, v12, v7, vcc
    v_lshl_add_u32 v11, v5, 2, v1
    v_mul_u32_u24 v11, 43008, v11
    v_lshl_add_u32 v9, v6, 4, v11
    v_cmp_gt_u32 vcc, 2, v5
    s_nop 1
    v_cndmask_b32 v10, v12, v9, vcc
    buffer_load_dwordx4 v[16:19], v7, s[56:59], 0 offen offset:0
    buffer_load_dwordx4 v[20:23], v7, s[56:59], 0 offen offset:256
    buffer_load_dwordx4 v[24:27], v7, s[56:59], 0 offen offset:512
    buffer_load_dwordx4 v[28:31], v8, s[56:59], 0 offen offset:768
    s_lshl_b32 s8, s100, 6
    buffer_load_dwordx4 v[64:67], v9, s[52:55], s8 offen nt
    s_add_u32 s8, s8, 5376
    buffer_load_dwordx4 v[68:71], v9, s[52:55], s8 offen nt
    s_add_u32 s8, s8, 5376
    buffer_load_dwordx4 v[72:75], v9, s[52:55], s8 offen nt
    s_add_u32 s8, s8, 5376
    buffer_load_dwordx4 v[76:79], v9, s[52:55], s8 offen nt
    s_add_u32 s8, s8, 5376
    buffer_load_dwordx4 v[80:83], v9, s[52:55], s8 offen nt
    s_add_u32 s8, s8, 5376
    buffer_load_dwordx4 v[84:87], v9, s[52:55], s8 offen nt
    s_add_u32 s8, s8, 5376
    buffer_load_dwordx4 v[88:91], v9, s[52:55], s8 offen nt
    s_add_u32 s8, s8, 5376
    buffer_load_dwordx4 v[92:95], v9, s[52:55], s8 offen nt
    s_add_u32 s8, s8, 650496
    buffer_load_dwordx4 v[96:99], v9, s[52:55], s8 offen nt
    s_add_u32 s8, s8, 5376
    buffer_load_dwordx4 v[100:103], v9, s[52:55], s8 offen nt
    s_add_u32 s8, s8, 5376
    buffer_load_dwordx4 v[104:107], v9, s[52:55], s8 offen nt
    s_add_u32 s8, s8, 5376
    buffer_load_dwordx4 v[108:111], v9, s[52:55], s8 offen nt
    s_add_u32 s8, s8, 5376
    buffer_load_dwordx4 v[112:115], v9, s[52:55], s8 offen nt
    s_add_u32 s8, s8, 5376
    buffer_load_dwordx4 v[116:119], v9, s[52:55], s8 offen nt
    s_add_u32 s8, s8, 5376
    buffer_load_dwordx4 v[120:123], v9, s[52:55], s8 offen nt
    s_add_u32 s8, s8, 5376
    buffer_load_dwordx4 v[124:127], v9, s[52:55], s8 offen nt
    s_add_u32 s8, s8, 650496
    buffer_load_dwordx4 v[128:131], v9, s[52:55], s8 offen nt
    s_add_u32 s8, s8, 5376
    buffer_load_dwordx4 v[132:135], v9, s[52:55], s8 offen nt
    s_add_u32 s8, s8, 5376
    buffer_load_dwordx4 v[136:139], v9, s[52:55], s8 offen nt
    s_add_u32 s8, s8, 5376
    buffer_load_dwordx4 v[140:143], v9, s[52:55], s8 offen nt
    s_add_u32 s8, s8, 5376
    buffer_load_dwordx4 v[144:147], v9, s[52:55], s8 offen nt
    s_add_u32 s8, s8, 5376
    buffer_load_dwordx4 v[148:151], v9, s[52:55], s8 offen nt
    s_add_u32 s8, s8, 5376
    buffer_load_dwordx4 v[152:155], v9, s[52:55], s8 offen nt
    s_add_u32 s8, s8, 5376
    buffer_load_dwordx4 v[156:159], v9, s[52:55], s8 offen nt
    s_add_u32 s8, s8, 650496
    buffer_load_dwordx4 v[160:163], v10, s[52:55], s8 offen nt
    s_add_u32 s8, s8, 5376
    buffer_load_dwordx4 v[164:167], v10, s[52:55], s8 offen nt
    s_add_u32 s8, s8, 5376
    buffer_load_dwordx4 v[168:171], v10, s[52:55], s8 offen nt
    s_add_u32 s8, s8, 5376
    buffer_load_dwordx4 v[172:175], v10, s[52:55], s8 offen nt
    s_add_u32 s8, s8, 5376
    buffer_load_dwordx4 v[176:179], v10, s[52:55], s8 offen nt
    s_add_u32 s8, s8, 5376
    buffer_load_dwordx4 v[180:183], v10, s[52:55], s8 offen nt
    s_add_u32 s8, s8, 5376
    buffer_load_dwordx4 v[184:187], v10, s[52:55], s8 offen nt
    s_add_u32 s8, s8, 5376
    buffer_load_dwordx4 v[188:191], v10, s[52:55], s8 offen nt
    s_add_u32 s8, s8, 650496
    s_barrier
    s_waitcnt vmcnt(32)
    s_mov_b32 s8, 0xbfb8aa3b
    v_lshlrev_b32 v13, 16, v16
    v_and_b32 v14, 0xffff0000, v16
    v_mul_f32 v11, s8, v13
    v_mul_f32 v12, s8, v14
    v_exp_f32 v11, v11
    v_exp_f32 v12, v12
    v_add_f32 v11, 1.0, v11
    v_add_f32 v12, 1.0, v12
    v_rcp_f32 v11, v11
    v_rcp_f32 v12, v12
    v_mul_f32 v11, v13, v11
    v_mul_f32 v12, v14, v12
    v_cvt_pk_bf16_f32 v16, v11, v12
    v_lshlrev_b32 v13, 16, v17
    v_and_b32 v14, 0xffff0000, v17
    v_mul_f32 v11, s8, v13
    v_mul_f32 v12, s8, v14
    v_exp_f32 v11, v11
    v_exp_f32 v12, v12
    v_add_f32 v11, 1.0, v11
    v_add_f32 v12, 1.0, v12
    v_rcp_f32 v11, v11
    v_rcp_f32 v12, v12
    v_mul_f32 v11, v13, v11
    v_mul_f32 v12, v14, v12
    v_cvt_pk_bf16_f32 v17, v11, v12
    v_lshlrev_b32 v13, 16, v18
    v_and_b32 v14, 0xffff0000, v18
    v_mul_f32 v11, s8, v13
    v_mul_f32 v12, s8, v14
    v_exp_f32 v11, v11
    v_exp_f32 v12, v12
    v_add_f32 v11, 1.0, v11
    v_add_f32 v12, 1.0, v12
    v_rcp_f32 v11, v11
    v_rcp_f32 v12, v12
    v_mul_f32 v11, v13, v11
    v_mul_f32 v12, v14, v12
    v_cvt_pk_bf16_f32 v18, v11, v12
    v_lshlrev_b32 v13, 16, v19
    v_and_b32 v14, 0xffff0000, v19
    v_mul_f32 v11, s8, v13
    v_mul_f32 v12, s8, v14
    v_exp_f32 v11, v11
    v_exp_f32 v12, v12
    v_add_f32 v11, 1.0, v11
    v_add_f32 v12, 1.0, v12
    v_rcp_f32 v11, v11
    v_rcp_f32 v12, v12
    v_mul_f32 v11, v13, v11
    v_mul_f32 v12, v14, v12
    v_cvt_pk_bf16_f32 v19, v11, v12
    v_lshlrev_b32 v13, 16, v20
    v_and_b32 v14, 0xffff0000, v20
    v_mul_f32 v11, s8, v13
    v_mul_f32 v12, s8, v14
    v_exp_f32 v11, v11
    v_exp_f32 v12, v12
    v_add_f32 v11, 1.0, v11
    v_add_f32 v12, 1.0, v12
    v_rcp_f32 v11, v11
    v_rcp_f32 v12, v12
    v_mul_f32 v11, v13, v11
    v_mul_f32 v12, v14, v12
    v_cvt_pk_bf16_f32 v20, v11, v12
    v_lshlrev_b32 v13, 16, v21
    v_and_b32 v14, 0xffff0000, v21
    v_mul_f32 v11, s8, v13
    v_mul_f32 v12, s8, v14
    v_exp_f32 v11, v11
    v_exp_f32 v12, v12
    v_add_f32 v11, 1.0, v11
    v_add_f32 v12, 1.0, v12
    v_rcp_f32 v11, v11
    v_rcp_f32 v12, v12
    v_mul_f32 v11, v13, v11
    v_mul_f32 v12, v14, v12
    v_cvt_pk_bf16_f32 v21, v11, v12
    v_lshlrev_b32 v13, 16, v22
    v_and_b32 v14, 0xffff0000, v22
    v_mul_f32 v11, s8, v13
    v_mul_f32 v12, s8, v14
    v_exp_f32 v11, v11
    v_exp_f32 v12, v12
    v_add_f32 v11, 1.0, v11
    v_add_f32 v12, 1.0, v12
    v_rcp_f32 v11, v11
    v_rcp_f32 v12, v12
    v_mul_f32 v11, v13, v11
    v_mul_f32 v12, v14, v12
    v_cvt_pk_bf16_f32 v22, v11, v12
    v_lshlrev_b32 v13, 16, v23
    v_and_b32 v14, 0xffff0000, v23
    v_mul_f32 v11, s8, v13
    v_mul_f32 v12, s8, v14
    v_exp_f32 v11, v11
    v_exp_f32 v12, v12
    v_add_f32 v11, 1.0, v11
    v_add_f32 v12, 1.0, v12
    v_rcp_f32 v11, v11
    v_rcp_f32 v12, v12
    v_mul_f32 v11, v13, v11
    v_mul_f32 v12, v14, v12
    v_cvt_pk_bf16_f32 v23, v11, v12
    v_lshlrev_b32 v13, 16, v24
    v_and_b32 v14, 0xffff0000, v24
    v_mul_f32 v11, s8, v13
    v_mul_f32 v12, s8, v14
    v_exp_f32 v11, v11
    v_exp_f32 v12, v12
    v_add_f32 v11, 1.0, v11
    v_add_f32 v12, 1.0, v12
    v_rcp_f32 v11, v11
    v_rcp_f32 v12, v12
    v_mul_f32 v11, v13, v11
    v_mul_f32 v12, v14, v12
    v_cvt_pk_bf16_f32 v24, v11, v12
    v_lshlrev_b32 v13, 16, v25
    v_and_b32 v14, 0xffff0000, v25
    v_mul_f32 v11, s8, v13
    v_mul_f32 v12, s8, v14
    v_exp_f32 v11, v11
    v_exp_f32 v12, v12
    v_add_f32 v11, 1.0, v11
    v_add_f32 v12, 1.0, v12
    v_rcp_f32 v11, v11
    v_rcp_f32 v12, v12
    v_mul_f32 v11, v13, v11
    v_mul_f32 v12, v14, v12
    v_cvt_pk_bf16_f32 v25, v11, v12
    v_lshlrev_b32 v13, 16, v26
    v_and_b32 v14, 0xffff0000, v26
    v_mul_f32 v11, s8, v13
    v_mul_f32 v12, s8, v14
    v_exp_f32 v11, v11
    v_exp_f32 v12, v12
    v_add_f32 v11, 1.0, v11
    v_add_f32 v12, 1.0, v12
    v_rcp_f32 v11, v11
    v_rcp_f32 v12, v12
    v_mul_f32 v11, v13, v11
    v_mul_f32 v12, v14, v12
    v_cvt_pk_bf16_f32 v26, v11, v12
    v_lshlrev_b32 v13, 16, v27
    v_and_b32 v14, 0xffff0000, v27
    v_mul_f32 v11, s8, v13
    v_mul_f32 v12, s8, v14
    v_exp_f32 v11, v11
    v_exp_f32 v12, v12
    v_add_f32 v11, 1.0, v11
    v_add_f32 v12, 1.0, v12
    v_rcp_f32 v11, v11
    v_rcp_f32 v12, v12
    v_mul_f32 v11, v13, v11
    v_mul_f32 v12, v14, v12
    v_cvt_pk_bf16_f32 v27, v11, v12
    v_lshlrev_b32 v13, 16, v28
    v_and_b32 v14, 0xffff0000, v28
    v_mul_f32 v11, s8, v13
    v_mul_f32 v12, s8, v14
    v_exp_f32 v11, v11
    v_exp_f32 v12, v12
    v_add_f32 v11, 1.0, v11
    v_add_f32 v12, 1.0, v12
    v_rcp_f32 v11, v11
    v_rcp_f32 v12, v12
    v_mul_f32 v11, v13, v11
    v_mul_f32 v12, v14, v12
    v_cvt_pk_bf16_f32 v28, v11, v12
    v_lshlrev_b32 v13, 16, v29
    v_and_b32 v14, 0xffff0000, v29
    v_mul_f32 v11, s8, v13
    v_mul_f32 v12, s8, v14
    v_exp_f32 v11, v11
    v_exp_f32 v12, v12
    v_add_f32 v11, 1.0, v11
    v_add_f32 v12, 1.0, v12
    v_rcp_f32 v11, v11
    v_rcp_f32 v12, v12
    v_mul_f32 v11, v13, v11
    v_mul_f32 v12, v14, v12
    v_cvt_pk_bf16_f32 v29, v11, v12
    v_lshlrev_b32 v13, 16, v30
    v_and_b32 v14, 0xffff0000, v30
    v_mul_f32 v11, s8, v13
    v_mul_f32 v12, s8, v14
    v_exp_f32 v11, v11
    v_exp_f32 v12, v12
    v_add_f32 v11, 1.0, v11
    v_add_f32 v12, 1.0, v12
    v_rcp_f32 v11, v11
    v_rcp_f32 v12, v12
    v_mul_f32 v11, v13, v11
    v_mul_f32 v12, v14, v12
    v_cvt_pk_bf16_f32 v30, v11, v12
    v_lshlrev_b32 v13, 16, v31
    v_and_b32 v14, 0xffff0000, v31
    v_mul_f32 v11, s8, v13
    v_mul_f32 v12, s8, v14
    v_exp_f32 v11, v11
    v_exp_f32 v12, v12
    v_add_f32 v11, 1.0, v11
    v_add_f32 v12, 1.0, v12
    v_rcp_f32 v11, v11
    v_rcp_f32 v12, v12
    v_mul_f32 v11, v13, v11
    v_mul_f32 v12, v14, v12
    v_cvt_pk_bf16_f32 v31, v11, v12
    s_waitcnt vmcnt(24)
    v_perm_b32 v32, v68, v64, s12
    v_perm_b32 v33, v76, v72, s12
    v_perm_b32 v34, v84, v80, s12
    v_perm_b32 v35, v92, v88, s12
    v_perm_b32 v36, v68, v64, s13
    v_perm_b32 v37, v76, v72, s13
    v_perm_b32 v38, v84, v80, s13
    v_perm_b32 v39, v92, v88, s13
    v_perm_b32 v40, v69, v65, s12
    v_perm_b32 v41, v77, v73, s12
    v_perm_b32 v42, v85, v81, s12
    v_perm_b32 v43, v93, v89, s12
    v_perm_b32 v44, v69, v65, s13
    v_perm_b32 v45, v77, v73, s13
    v_perm_b32 v46, v85, v81, s13
    v_perm_b32 v47, v93, v89, s13
    v_perm_b32 v48, v70, v66, s12
    v_perm_b32 v49, v78, v74, s12
    v_perm_b32 v50, v86, v82, s12
    v_perm_b32 v51, v94, v90, s12
    v_perm_b32 v52, v70, v66, s13
    v_perm_b32 v53, v78, v74, s13
    v_perm_b32 v54, v86, v82, s13
    v_perm_b32 v55, v94, v90, s13
    v_perm_b32 v56, v71, v67, s12
    v_perm_b32 v57, v79, v75, s12
    v_perm_b32 v58, v87, v83, s12
    v_perm_b32 v59, v95, v91, s12
    v_perm_b32 v60, v71, v67, s13
    v_perm_b32 v61, v79, v75, s13
    v_perm_b32 v62, v87, v83, s13
    v_perm_b32 v63, v95, v91, s13
    v_mfma_f32_16x16x32_bf16 v[192:195], v[16:19], v[32:35], 0
    v_mfma_f32_16x16x32_bf16 v[196:199], v[16:19], v[36:39], 0
    v_mfma_f32_16x16x32_bf16 v[200:203], v[16:19], v[40:43], 0
    v_mfma_f32_16x16x32_bf16 v[204:207], v[16:19], v[44:47], 0
    v_mfma_f32_16x16x32_bf16 v[208:211], v[16:19], v[48:51], 0
    v_mfma_f32_16x16x32_bf16 v[212:215], v[16:19], v[52:55], 0
    v_mfma_f32_16x16x32_bf16 v[216:219], v[16:19], v[56:59], 0
    v_mfma_f32_16x16x32_bf16 v[220:223], v[16:19], v[60:63], 0
    buffer_load_dword v251, off, s[48:51], 0 sc1
    s_waitcnt vmcnt(17)
    v_perm_b32 v64, v100, v96, s12
    v_perm_b32 v65, v108, v104, s12
    v_perm_b32 v66, v116, v112, s12
    v_perm_b32 v67, v124, v120, s12
    v_perm_b32 v68, v100, v96, s13
    v_perm_b32 v69, v108, v104, s13
    v_perm_b32 v70, v116, v112, s13
    v_perm_b32 v71, v124, v120, s13
    v_perm_b32 v72, v101, v97, s12
    v_perm_b32 v73, v109, v105, s12
    v_perm_b32 v74, v117, v113, s12
    v_perm_b32 v75, v125, v121, s12
    v_perm_b32 v76, v101, v97, s13
    v_perm_b32 v77, v109, v105, s13
    v_perm_b32 v78, v117, v113, s13
    v_perm_b32 v79, v125, v121, s13
    v_perm_b32 v80, v102, v98, s12
    v_perm_b32 v81, v110, v106, s12
    v_perm_b32 v82, v118, v114, s12
    v_perm_b32 v83, v126, v122, s12
    v_perm_b32 v84, v102, v98, s13
    v_perm_b32 v85, v110, v106, s13
    v_perm_b32 v86, v118, v114, s13
    v_perm_b32 v87, v126, v122, s13
    v_perm_b32 v88, v103, v99, s12
    v_perm_b32 v89, v111, v107, s12
    v_perm_b32 v90, v119, v115, s12
    v_perm_b32 v91, v127, v123, s12
    v_perm_b32 v92, v103, v99, s13
    v_perm_b32 v93, v111, v107, s13
    v_perm_b32 v94, v119, v115, s13
    v_perm_b32 v95, v127, v123, s13
    v_mfma_f32_16x16x32_bf16 v[192:195], v[20:23], v[64:67], v[192:195]
    v_mfma_f32_16x16x32_bf16 v[196:199], v[20:23], v[68:71], v[196:199]
    v_mfma_f32_16x16x32_bf16 v[200:203], v[20:23], v[72:75], v[200:203]
    v_mfma_f32_16x16x32_bf16 v[204:207], v[20:23], v[76:79], v[204:207]
    v_mfma_f32_16x16x32_bf16 v[208:211], v[20:23], v[80:83], v[208:211]
    v_mfma_f32_16x16x32_bf16 v[212:215], v[20:23], v[84:87], v[212:215]
    v_mfma_f32_16x16x32_bf16 v[216:219], v[20:23], v[88:91], v[216:219]
    v_mfma_f32_16x16x32_bf16 v[220:223], v[20:23], v[92:95], v[220:223]
    s_waitcnt vmcnt(9)
    v_perm_b32 v96, v132, v128, s12
    v_perm_b32 v97, v140, v136, s12
    v_perm_b32 v98, v148, v144, s12
    v_perm_b32 v99, v156, v152, s12
    v_perm_b32 v100, v132, v128, s13
    v_perm_b32 v101, v140, v136, s13
    v_perm_b32 v102, v148, v144, s13
    v_perm_b32 v103, v156, v152, s13
    v_perm_b32 v104, v133, v129, s12
    v_perm_b32 v105, v141, v137, s12
    v_perm_b32 v106, v149, v145, s12
    v_perm_b32 v107, v157, v153, s12
    v_perm_b32 v108, v133, v129, s13
    v_perm_b32 v109, v141, v137, s13
    v_perm_b32 v110, v149, v145, s13
    v_perm_b32 v111, v157, v153, s13
    v_perm_b32 v112, v134, v130, s12
    v_perm_b32 v113, v142, v138, s12
    v_perm_b32 v114, v150, v146, s12
    v_perm_b32 v115, v158, v154, s12
    v_perm_b32 v116, v134, v130, s13
    v_perm_b32 v117, v142, v138, s13
    v_perm_b32 v118, v150, v146, s13
    v_perm_b32 v119, v158, v154, s13
    v_perm_b32 v120, v135, v131, s12
    v_perm_b32 v121, v143, v139, s12
    v_perm_b32 v122, v151, v147, s12
    v_perm_b32 v123, v159, v155, s12
    v_perm_b32 v124, v135, v131, s13
    v_perm_b32 v125, v143, v139, s13
    v_perm_b32 v126, v151, v147, s13
    v_perm_b32 v127, v159, v155, s13
    v_mfma_f32_16x16x32_bf16 v[192:195], v[24:27], v[96:99], v[192:195]
    v_mfma_f32_16x16x32_bf16 v[196:199], v[24:27], v[100:103], v[196:199]
    v_mfma_f32_16x16x32_bf16 v[200:203], v[24:27], v[104:107], v[200:203]
    v_mfma_f32_16x16x32_bf16 v[204:207], v[24:27], v[108:111], v[204:207]
    v_mfma_f32_16x16x32_bf16 v[208:211], v[24:27], v[112:115], v[208:211]
    v_mfma_f32_16x16x32_bf16 v[212:215], v[24:27], v[116:119], v[212:215]
    v_mfma_f32_16x16x32_bf16 v[216:219], v[24:27], v[120:123], v[216:219]
    v_mfma_f32_16x16x32_bf16 v[220:223], v[24:27], v[124:127], v[220:223]
    s_waitcnt vmcnt(1)
    v_perm_b32 v128, v164, v160, s12
    v_perm_b32 v129, v172, v168, s12
    v_perm_b32 v130, v180, v176, s12
    v_perm_b32 v131, v188, v184, s12
    v_perm_b32 v132, v164, v160, s13
    v_perm_b32 v133, v172, v168, s13
    v_perm_b32 v134, v180, v176, s13
    v_perm_b32 v135, v188, v184, s13
    v_perm_b32 v136, v165, v161, s12
    v_perm_b32 v137, v173, v169, s12
    v_perm_b32 v138, v181, v177, s12
    v_perm_b32 v139, v189, v185, s12
    v_perm_b32 v140, v165, v161, s13
    v_perm_b32 v141, v173, v169, s13
    v_perm_b32 v142, v181, v177, s13
    v_perm_b32 v143, v189, v185, s13
    v_perm_b32 v144, v166, v162, s12
    v_perm_b32 v145, v174, v170, s12
    v_perm_b32 v146, v182, v178, s12
    v_perm_b32 v147, v190, v186, s12
    v_perm_b32 v148, v166, v162, s13
    v_perm_b32 v149, v174, v170, s13
    v_perm_b32 v150, v182, v178, s13
    v_perm_b32 v151, v190, v186, s13
    v_perm_b32 v152, v167, v163, s12
    v_perm_b32 v153, v175, v171, s12
    v_perm_b32 v154, v183, v179, s12
    v_perm_b32 v155, v191, v187, s12
    v_perm_b32 v156, v167, v163, s13
    v_perm_b32 v157, v175, v171, s13
    v_perm_b32 v158, v183, v179, s13
    v_perm_b32 v159, v191, v187, s13
    v_mfma_f32_16x16x32_bf16 v[192:195], v[28:31], v[128:131], v[192:195]
    v_mfma_f32_16x16x32_bf16 v[196:199], v[28:31], v[132:135], v[196:199]
    v_mfma_f32_16x16x32_bf16 v[200:203], v[28:31], v[136:139], v[200:203]
    v_mfma_f32_16x16x32_bf16 v[204:207], v[28:31], v[140:143], v[204:207]
    v_mfma_f32_16x16x32_bf16 v[208:211], v[28:31], v[144:147], v[208:211]
    v_mfma_f32_16x16x32_bf16 v[212:215], v[28:31], v[148:151], v[212:215]
    v_mfma_f32_16x16x32_bf16 v[216:219], v[28:31], v[152:155], v[216:219]
    v_mfma_f32_16x16x32_bf16 v[220:223], v[28:31], v[156:159], v[220:223]
    v_mul_u32_u24 v11, 5376, v1
    v_lshl_add_u32 v11, v2, 4, v11
    v_cmp_gt_u32 vcc, 4, v2
    v_mov_b32 v12, 1073741824
    s_nop 0
    v_cndmask_b32 v11, v12, v11, vcc
    v_add_f32_dpp v192, v193, v192 row_shl:4 row_mask:0xf bank_mask:0xf
    v_add_f32_dpp v196, v197, v196 row_shl:4 row_mask:0xf bank_mask:0xf
    v_add_f32_dpp v200, v201, v200 row_shl:4 row_mask:0xf bank_mask:0xf
    v_add_f32_dpp v204, v205, v204 row_shl:4 row_mask:0xf bank_mask:0xf
    v_add_f32_dpp v208, v209, v208 row_shl:4 row_mask:0xf bank_mask:0xf
    v_add_f32_dpp v212, v213, v212 row_shl:4 row_mask:0xf bank_mask:0xf
    v_add_f32_dpp v216, v217, v216 row_shl:4 row_mask:0xf bank_mask:0xf
    v_add_f32_dpp v220, v221, v220 row_shl:4 row_mask:0xf bank_mask:0xf
    v_add_f32_dpp v192, v194, v192 row_shl:8 row_mask:0xf bank_mask:0xf
    v_add_f32_dpp v196, v198, v196 row_shl:8 row_mask:0xf bank_mask:0xf
    v_add_f32_dpp v200, v202, v200 row_shl:8 row_mask:0xf bank_mask:0xf
    v_add_f32_dpp v204, v206, v204 row_shl:8 row_mask:0xf bank_mask:0xf
    v_add_f32_dpp v208, v210, v208 row_shl:8 row_mask:0xf bank_mask:0xf
    v_add_f32_dpp v212, v214, v212 row_shl:8 row_mask:0xf bank_mask:0xf
    v_add_f32_dpp v216, v218, v216 row_shl:8 row_mask:0xf bank_mask:0xf
    v_add_f32_dpp v220, v222, v220 row_shl:8 row_mask:0xf bank_mask:0xf
    v_add_f32_dpp v192, v195, v192 row_shl:12 row_mask:0xf bank_mask:0xf
    v_add_f32_dpp v196, v199, v196 row_shl:12 row_mask:0xf bank_mask:0xf
    v_add_f32_dpp v200, v203, v200 row_shl:12 row_mask:0xf bank_mask:0xf
    v_add_f32_dpp v204, v207, v204 row_shl:12 row_mask:0xf bank_mask:0xf
    v_add_f32_dpp v208, v211, v208 row_shl:12 row_mask:0xf bank_mask:0xf
    v_add_f32_dpp v212, v215, v212 row_shl:12 row_mask:0xf bank_mask:0xf
    v_add_f32_dpp v216, v219, v216 row_shl:12 row_mask:0xf bank_mask:0xf
    v_add_f32_dpp v220, v223, v220 row_shl:12 row_mask:0xf bank_mask:0xf
    v_cvt_pk_bf16_f32 v12, v192, v196
    v_cvt_pk_bf16_f32 v13, v200, v204
    v_cvt_pk_bf16_f32 v14, v208, v212
    v_cvt_pk_bf16_f32 v15, v216, v220
    s_mov_b32 s8, 0
    s_sub_u32 s9, s100, 14
    s_cmp_lt_u32 s9, 14
    s_cselect_b32 s8, 1.0, s8
    v_lshlrev_b32 v16, 16, v12
    v_and_b32 v17, 0xffff0000, v12
    v_add_f32 v16, s8, v16
    v_add_f32 v17, s8, v17
    v_cvt_pk_bf16_f32 v12, v16, v17
    v_min_u32 v12, -2, v12
    v_lshlrev_b32 v16, 16, v13
    v_and_b32 v17, 0xffff0000, v13
    v_add_f32 v16, s8, v16
    v_add_f32 v17, s8, v17
    v_cvt_pk_bf16_f32 v13, v16, v17
    v_min_u32 v13, -2, v13
    v_lshlrev_b32 v16, 16, v14
    v_and_b32 v17, 0xffff0000, v14
    v_add_f32 v16, s8, v16
    v_add_f32 v17, s8, v17
    v_cvt_pk_bf16_f32 v14, v16, v17
    v_min_u32 v14, -2, v14
    v_lshlrev_b32 v16, 16, v15
    v_and_b32 v17, 0xffff0000, v15
    v_add_f32 v16, s8, v16
    v_add_f32 v17, s8, v17
    v_cvt_pk_bf16_f32 v15, v16, v17
    v_min_u32 v15, -2, v15
    s_lshl_b32 s8, s100, 6
    s_add_u32 s8, s8, 8192
    s_waitcnt vmcnt(0)
    v_cmp_ne_u32 vcc, 0, v251
    s_nop 0
    s_cbranch_vccnz L_mt1
    s_mov_b32 s15, 0
L_pf9:
    buffer_load_dword v3, off, s[48:51], 0 offset:0 sc1
    s_waitcnt vmcnt(0)
    v_readfirstlane_b32 s11, v3
    s_cmp_lg_u32 s11, 0
    s_nop 2
    s_cbranch_scc1 L_pf9_ok
    s_sleep 4
    s_add_u32 s15, s15, 1
    s_cmp_lt_u32 s15, 1000000
    s_cbranch_scc1 L_pf9
L_pf9_ok:
L_mt1:
    buffer_store_dwordx4 v[12:15], v11, s[44:47], s8 offen sc1
L_hm:
    s_waitcnt vmcnt(0)
    v_not_b32 v252, v252
    v_not_b32 v253, v253
    v_not_b32 v254, v254
    v_not_b32 v255, v255
    s_lshl_b32 s9, s3, 10
    v_lshl_add_u32 v11, v0, 4, s9
    v_add_u32 v13, 65536, v11
    v_add_u32 v14, 131072, v11
    v_mov_b32 v12, 148544
    v_lshlrev_b32 v15, 3, v0
    v_add_u32 v12, 148544, v15
    v_mov_b32 v16, 0xff800000
    v_mov_b32 v17, 0
    s_barrier
    s_cmp_eq_u32 s3, 1
    s_cbranch_scc1 L_hm2
    s_mov_b64 exec, 0xfff
    ds_read_b64 v[16:17], v12
    s_mov_b64 exec, -1
    s_waitcnt lgkmcnt(0)
    v_max_f32_dpp v18, v16, v16 row_ror:8 row_mask:0xf bank_mask:0xf
    s_nop 1
    v_max_f32_dpp v18, v18, v18 row_ror:4 row_mask:0xf bank_mask:0xf
    s_nop 1
    v_max_f32_dpp v18, v18, v18 row_ror:2 row_mask:0xf bank_mask:0xf
    v_sub_f32 v16, v16, v18
    v_mul_f32 v16, s14, v16
    v_exp_f32 v16, v16
    s_nop 0
    v_mul_f32 v19, v16, v17
    s_nop 1
    v_add_f32_dpp v19, v19, v19 row_ror:8 row_mask:0xf bank_mask:0xf
    s_nop 1
    v_add_f32_dpp v19, v19, v19 row_ror:4 row_mask:0xf bank_mask:0xf
    s_nop 1
    v_add_f32_dpp v19, v19, v19 row_ror:2 row_mask:0xf bank_mask:0xf
    s_mov_b64 exec, 3
    buffer_store_dwordx2 v[18:19], v15, s[44:47], s63 offen sc1
    s_mov_b64 exec, -1
L_hm2:
    s_barrier
    ds_read_b128 v[224:227], v11 offset:0
    ds_read_b128 v[228:231], v11 offset:32768
    ds_read_b128 v[232:235], v13 offset:0
    ds_read_b128 v[236:239], v13 offset:32768
    ds_read_b128 v[240:243], v14 offset:0
    ds_read_b128 v[244:247], v14 offset:8192
    s_waitcnt lgkmcnt(4)
    v_pk_add_f32 v[224:225], v[224:225], v[228:229]
    v_pk_add_f32 v[226:227], v[226:227], v[230:231]
    s_waitcnt lgkmcnt(3)
    v_pk_add_f32 v[224:225], v[224:225], v[232:233]
    v_pk_add_f32 v[226:227], v[226:227], v[234:235]
    s_waitcnt lgkmcnt(2)
    v_pk_add_f32 v[224:225], v[224:225], v[236:237]
    v_pk_add_f32 v[226:227], v[226:227], v[238:239]
    s_waitcnt lgkmcnt(1)
    v_pk_add_f32 v[224:225], v[224:225], v[240:241]
    v_pk_add_f32 v[226:227], v[226:227], v[242:243]
    s_waitcnt lgkmcnt(0)
    v_pk_add_f32 v[224:225], v[224:225], v[244:245]
    v_pk_add_f32 v[226:227], v[226:227], v[246:247]
    v_bfi_b32 v224, 1, v252, v224
    v_bfi_b32 v225, 1, v253, v225
    v_bfi_b32 v226, 1, v254, v226
    v_bfi_b32 v227, 1, v255, v227
    buffer_store_dwordx4 v[224:227], v250, s[44:47], s62 offen sc1
L_hdone:
    s_endpgm
L_sx:
    s_getreg_b32 s99, hwreg(HW_REG_XCC_ID, 0, 4)
    v_lshrrev_b32 v5, 2, v2
    v_and_b32 v6, 3, v0
    v_cmp_gt_u32 s[64:65], 56, v0
    s_and_b32 s79, s3, 3
    v_cmp_eq_u32 s[66:67], 1, v1
    v_cmp_eq_u32 s[68:69], 2, v1
    v_cmp_eq_u32 s[70:71], 3, v1
    s_waitcnt lgkmcnt(0)
    s_mov_b32 s44, s42
    s_mov_b32 s45, s43
    s_mov_b32 s46, 1310720
    s_mov_b32 s47, 0x20000
    s_mov_b32 s48, s40
    s_mov_b32 s49, s41
    s_mov_b32 s50, 256
    s_mov_b32 s51, 0x20000
    v_mov_b32 v12, 1073741824
    v_lshlrev_b32 v11, 4, v2
    v_lshl_add_u32 v9, v1, 9, v11
    v_add_u32 v13, 2048, v9
    v_cndmask_b32 v10, v13, v12, s[70:71]
    s_lshr_b32 s8, s3, 1
    s_and_b32 s9, s3, 1
    s_lshl_b32 s11, s4, 14
    s_lshl_b32 s10, s8, 12
    s_add_u32 s11, s11, s10
    s_lshl_b32 s10, s9, 8
    s_add_u32 s11, s11, s10
    s_add_u32 s11, s11, 131072
    buffer_load_dwordx4 v[152:155], v9, s[44:47], s11 offen sc1
    buffer_load_dwordx4 v[156:159], v10, s[44:47], s11 offen sc1
    s_cmp_lt_u32 s3, 4
    s_cbranch_scc1 L_sxh
    s_cmp_lg_u32 s2, 247
    s_cbranch_scc1 L_sxd
    s_cmp_lg_u32 s3, 7
    s_cbranch_scc1 L_sxd
    s_getpc_b64 s[10:11]
L_cp10:
    v_lshlrev_b32 v3, 7, v0
    v_min_u32 v4, L_end-L_cp10, v3
    v_mov_b32 v23, s11
    v_add_co_u32 v22, vcc, s10, v4
    s_nop 1
    v_addc_co_u32 v23, vcc, 0, v23, vcc
    global_load_dword v20, v[22:23], off
    v_add_u32 v3, 8192, v3
    v_min_u32 v4, L_end-L_cp10, v3
    v_mov_b32 v23, s11
    v_add_co_u32 v22, vcc, s10, v4
    s_nop 1
    v_addc_co_u32 v23, vcc, 0, v23, vcc
    global_load_dword v21, v[22:23], off
    v_add_u32 v3, 8192, v3
L_sxd:
    s_mov_b32 s52, s22
    s_mov_b32 s53, s23
    s_mov_b32 s54, 3670016
    s_mov_b32 s55, 0x20000
    v_lshlrev_b32 v11, 1, v1
    v_xor_b32 v11, v11, v2
    v_lshlrev_b32 v11, 4, v11
    v_lshl_add_u32 v7, v1, 13, v11
    v_xor_b32 v8, 128, v7
    s_mul_i32 s8, s79, 917504
    s_lshl_b32 s9, s4, 8
    s_add_u32 s8, s8, s9
    s_mul_i32 s9, s79, 28672
    s_mov_b32 s10, 0
L_sxdl:
    s_add_u32 m0, s9, 0
    s_waitcnt vmcnt(9)
    buffer_load_dwordx4 v7, s[52:55], s8 offen nt lds
    s_add_u32 s8, s8, 32768
    s_add_u32 m0, s9, 1024
    s_waitcnt vmcnt(9)
    buffer_load_dwordx4 v7, s[52:55], s8 offen nt lds
    s_add_u32 s8, s8, 32768
    s_add_u32 m0, s9, 2048
    s_waitcnt vmcnt(9)
    buffer_load_dwordx4 v8, s[52:55], s8 offen nt lds
    s_add_u32 s8, s8, 32768
    s_add_u32 m0, s9, 3072
    s_waitcnt vmcnt(9)
    buffer_load_dwordx4 v8, s[52:55], s8 offen nt lds
    s_add_u32 s8, s8, 32768
    s_add_u32 s9, s9, 4096
    s_add_u32 s10, s10, 1
    s_cmp_lt_u32 s10, 7
    s_cbranch_scc1 L_sxdl
    s_mov_b32 s60, s24
    s_mov_b32 s61, s25
    s_mov_b32 s62, 3670016
    s_mov_b32 s63, 0x20000
    v_bfe_u32 v11, v0, 3, 1
    v_lshlrev_b32 v11, 8, v11
    v_bfe_u32 v12, v0, 4, 1
    v_lshl_add_u32 v11, v12, 7, v11
    v_lshrrev_b32 v13, 5, v0
    v_lshl_add_u32 v11, v13, 3, v11
    v_mul_u32_u24 v11, 896, v11
    v_and_b32 v13, 7, v0
    v_lshlrev_b32 v12, 1, v12
    v_xor_b32 v13, v13, v12
    v_lshlrev_b32 v28, 4, v13
    s_cmp_eq_u32 s3, 7
    s_cselect_b32 s9, 1073741824, 0
    v_add3_u32 v30, v11, v28, s9
    v_xor_b32 v31, 64, v30
    s_lshr_b32 s78, s4, 2
    s_lshl_b32 s78, s78, 9
    s_and_b32 s9, s4, 3
    s_lshl_b32 s9, s9, 1
    s_add_u32 s78, s78, s9
    s_mul_i32 s78, s78, 896
    s_lshl_b32 s9, s3, 7
    s_add_u32 s78, s78, s9
    s_waitcnt vmcnt(9)
    s_add_u32 s9, s78, 0
    buffer_load_dwordx4 v[32:35], v30, s[60:63], s9 offen offset:0 nt
    s_waitcnt vmcnt(9)
    s_add_u32 s9, s78, 14336
    buffer_load_dwordx4 v[40:43], v31, s[60:63], s9 offen offset:0 nt
    s_waitcnt vmcnt(9)
    s_add_u32 s9, s78, 28672
    buffer_load_dwordx4 v[48:51], v30, s[60:63], s9 offen offset:0 nt
    s_waitcnt vmcnt(9)
    s_add_u32 s9, s78, 43008
    buffer_load_dwordx4 v[56:59], v31, s[60:63], s9 offen offset:0 nt
    s_waitcnt vmcnt(9)
    s_add_u32 s9, s78, 57344
    buffer_load_dwordx4 v[36:39], v30, s[60:63], s9 offen offset:0 nt
    s_waitcnt vmcnt(9)
    s_add_u32 s9, s78, 71680
    buffer_load_dwordx4 v[44:47], v31, s[60:63], s9 offen offset:0 nt
    s_waitcnt vmcnt(9)
    s_add_u32 s9, s78, 86016
    buffer_load_dwordx4 v[52:55], v30, s[60:63], s9 offen offset:0 nt
    s_waitcnt vmcnt(9)
    s_add_u32 s9, s78, 100352
    buffer_load_dwordx4 v[60:63], v31, s[60:63], s9 offen offset:0 nt
    s_waitcnt vmcnt(9)
    s_add_u32 s9, s78, 0
    buffer_load_dwordx4 v[64:67], v30, s[60:63], s9 offen offset:896 nt
    s_waitcnt vmcnt(9)
    s_add_u32 s9, s78, 14336
    buffer_load_dwordx4 v[72:75], v31, s[60:63], s9 offen offset:896 nt
    s_waitcnt vmcnt(9)
    s_add_u32 s9, s78, 28672
    buffer_load_dwordx4 v[80:83], v30, s[60:63], s9 offen offset:896 nt
    s_waitcnt vmcnt(9)
    s_add_u32 s9, s78, 43008
    buffer_load_dwordx4 v[88:91], v31, s[60:63], s9 offen offset:896 nt
    s_waitcnt vmcnt(9)
    s_add_u32 s9, s78, 57344
    buffer_load_dwordx4 v[68:71], v30, s[60:63], s9 offen offset:896 nt
    s_waitcnt vmcnt(9)
    s_add_u32 s9, s78, 71680
    buffer_load_dwordx4 v[76:79], v31, s[60:63], s9 offen offset:896 nt
    s_waitcnt vmcnt(9)
    s_add_u32 s9, s78, 86016
    buffer_load_dwordx4 v[84:87], v30, s[60:63], s9 offen offset:896 nt
    s_waitcnt vmcnt(9)
    s_add_u32 s9, s78, 100352
    buffer_load_dwordx4 v[92:95], v31, s[60:63], s9 offen offset:896 nt
    s_waitcnt vmcnt(16)
    s_branch L_sxq
L_sxh:
    s_mov_b32 s52, s16
    s_mov_b32 s53, s17
    s_mov_b32 s54, 3584
    s_mov_b32 s55, 0x20000
    v_lshlrev_b32 v7, 4, v0
    v_mov_b32 v12, 1073741824
    v_cndmask_b32 v8, v12, v7, s[64:65]
    s_mul_i32 s8, s79, 896
    buffer_load_dwordx4 v[16:19], v8, s[52:55], s8 offen
    s_cmp_lg_u32 s3, 0
    s_cbranch_scc1 L_sxh1
    s_mul_i32 s8, s99, s99
    s_lshl_b32 s8, s8, 16
    s_lshl_b32 s9, s99, 6
    s_add_u32 s8, s8, s9
    s_add_u32 s8, s8, 1
    s_mov_b32 s9, s8
    s_atomic_add s9, s[40:41], 132 glc
    s_waitcnt lgkmcnt(0)
    s_add_u32 s9, s9, s8
    s_and_b32 s10, s9, 63
    s_cmp_lg_u32 s10, 32
    s_cbranch_scc1 L_ax11
    s_lshl_b32 s8, s8, 5
    s_cmp_eq_u32 s8, s9
    s_cselect_b32 s8, 2, 1
    s_mov_b64 exec, 1
    v_mov_b32 v3, s8
    buffer_store_dword v3, off, s[48:51], 0 offset:8 sc1
    s_mov_b64 exec, -1
L_ax11:
L_sxh1:
    v_mov_b32 v20, -1
    v_mov_b32 v21, -1
    v_mov_b32 v22, -1
    v_mov_b32 v23, -1
    s_lshl_b32 s8, s4, 10
    s_lshl_b32 s9, s3, 8
    s_add_u32 s8, s8, s9
    s_add_u32 s8, s8, 1085440
    v_lshlrev_b32 v9, 7, v0
    s_mov_b64 exec, 3
    buffer_store_dwordx4 v[20:23], v9, s[44:47], s8 offen sc1
    s_mov_b64 exec, -1
    s_mov_b32 s60, s24
    s_mov_b32 s61, s25
    s_mov_b32 s62, 3670016
    s_mov_b32 s63, 0x20000
    v_bfe_u32 v11, v0, 3, 1
    v_lshlrev_b32 v11, 8, v11
    v_bfe_u32 v12, v0, 4, 1
    v_lshl_add_u32 v11, v12, 7, v11
    v_lshrrev_b32 v13, 5, v0
    v_lshl_add_u32 v11, v13, 3, v11
    v_mul_u32_u24 v11, 896, v11
    v_and_b32 v13, 7, v0
    v_lshlrev_b32 v12, 1, v12
    v_xor_b32 v13, v13, v12
    v_lshlrev_b32 v28, 4, v13
    s_cmp_eq_u32 s3, 7
    s_cselect_b32 s9, 1073741824, 0
    v_add3_u32 v30, v11, v28, s9
    v_xor_b32 v31, 64, v30
    s_lshr_b32 s78, s4, 2
    s_lshl_b32 s78, s78, 9
    s_and_b32 s9, s4, 3
    s_lshl_b32 s9, s9, 1
    s_add_u32 s78, s78, s9
    s_mul_i32 s78, s78, 896
    s_lshl_b32 s9, s3, 7
    s_add_u32 s78, s78, s9
    s_waitcnt vmcnt(1)
    v_readfirstlane_b32 s11, v16
    v_lshlrev_b32 v224, 16, v16
    v_and_b32 v225, 0xffff0000, v16
    v_lshlrev_b32 v226, 16, v17
    v_and_b32 v227, 0xffff0000, v17
    v_lshlrev_b32 v228, 16, v18
    v_and_b32 v229, 0xffff0000, v18
    v_lshlrev_b32 v230, 16, v19
    v_and_b32 v231, 0xffff0000, v19
    s_lshl_b32 s11, s11, 16
    v_mov_b32 v10, s11
    v_pk_add_f32 v[232:233], v[224:225], v[10:11] op_sel_hi:[1,0] neg_lo:[0,1] neg_hi:[0,1]
    v_pk_add_f32 v[234:235], v[226:227], v[10:11] op_sel_hi:[1,0] neg_lo:[0,1] neg_hi:[0,1]
    v_pk_add_f32 v[236:237], v[228:229], v[10:11] op_sel_hi:[1,0] neg_lo:[0,1] neg_hi:[0,1]
    v_pk_add_f32 v[238:239], v[230:231], v[10:11] op_sel_hi:[1,0] neg_lo:[0,1] neg_hi:[0,1]
    v_pk_add_f32 v[12:13], v[232:233], v[234:235]
    v_pk_mul_f32 v[14:15], v[232:233], v[232:233]
    v_pk_add_f32 v[10:11], v[236:237], v[238:239]
    v_pk_fma_f32 v[14:15], v[234:235], v[234:235], v[14:15]
    v_pk_add_f32 v[12:13], v[12:13], v[10:11]
    v_pk_fma_f32 v[14:15], v[236:237], v[236:237], v[14:15]
    v_pk_fma_f32 v[14:15], v[238:239], v[238:239], v[14:15]
    v_add_f32 v10, v12, v13
    v_add_f32 v12, v14, v15
    v_cndmask_b32 v10, 0, v10, s[64:65]
    v_cndmask_b32 v12, 0, v12, s[64:65]
    s_nop 1
    v_permlane32_swap_b32 v10, v12
    v_add_f32 v10, v10, v12
    v_mov_b32 v12, v10
    s_nop 1
    v_permlane16_swap_b32 v10, v12
    v_add_f32 v10, v10, v12
    s_nop 1
    v_add_f32_dpp v10, v10, v10 row_ror:8 row_mask:0xf bank_mask:0xf
    s_nop 1
    v_add_f32_dpp v10, v10, v10 row_ror:4 row_mask:0xf bank_mask:0xf
    s_nop 1
    v_add_f32_dpp v10, v10, v10 row_ror:2 row_mask:0xf bank_mask:0xf
    s_nop 1
    v_add_f32_dpp v10, v10, v10 row_ror:1 row_mask:0xf bank_mask:0xf
    v_mul_f32 v10, 0x3b124925, v10
    v_mov_b32 v12, v10
    s_nop 1
    v_permlane32_swap_b32 v10, v12
    v_fma_f32 v12, -v10, v10, v12
    v_add_f32 v10, s11, v10
    v_max_f32 v12, 0, v12
    v_cvt_pk_bf16_f32 v10, 0, v10
    v_cvt_pk_bf16_f32 v12, 0, v12
    v_add_f32 v12, 0x3727c5ac, v12
    v_pk_add_f32 v[224:225], v[224:225], v[10:11] op_sel_hi:[1,0] neg_lo:[0,1] neg_hi:[0,1]
    v_pk_add_f32 v[226:227], v[226:227], v[10:11] op_sel_hi:[1,0] neg_lo:[0,1] neg_hi:[0,1]
    v_cvt_pk_bf16_f32 v12, 0, v12
    v_sqrt_f32 v12, v12
    v_pk_add_f32 v[228:229], v[228:229], v[10:11] op_sel_hi:[1,0] neg_lo:[0,1] neg_hi:[0,1]
    v_pk_add_f32 v[230:231], v[230:231], v[10:11] op_sel_hi:[1,0] neg_lo:[0,1] neg_hi:[0,1]
    v_cvt_pk_bf16_f32 v224, 0, v224
    v_cvt_pk_bf16_f32 v225, 0, v225
    v_cvt_pk_bf16_f32 v12, 0, v12
    v_rcp_f32 v12, v12
    v_cvt_pk_bf16_f32 v226, 0, v226
    v_cvt_pk_bf16_f32 v227, 0, v227
    v_cvt_pk_bf16_f32 v228, 0, v228
    v_cvt_pk_bf16_f32 v229, 0, v229
    v_cvt_pk_bf16_f32 v230, 0, v230
    v_cvt_pk_bf16_f32 v231, 0, v231
    v_pk_mul_f32 v[224:225], v[224:225], v[12:13] op_sel_hi:[1,0]
    v_pk_mul_f32 v[226:227], v[226:227], v[12:13] op_sel_hi:[1,0]
    v_pk_mul_f32 v[228:229], v[228:229], v[12:13] op_sel_hi:[1,0]
    v_pk_mul_f32 v[230:231], v[230:231], v[12:13] op_sel_hi:[1,0]
    v_cvt_pk_bf16_f32 v224, 0, v224
    v_cvt_pk_bf16_f32 v225, 0, v225
    v_cvt_pk_bf16_f32 v226, 0, v226
    v_cvt_pk_bf16_f32 v227, 0, v227
    v_cvt_pk_bf16_f32 v228, 0, v228
    v_cvt_pk_bf16_f32 v229, 0, v229
    v_cvt_pk_bf16_f32 v230, 0, v230
    v_cvt_pk_bf16_f32 v231, 0, v231
    s_mov_b32 s15, 0
L_pf12:
    buffer_load_dword v3, off, s[48:51], 0 offset:0 sc1
    s_waitcnt vmcnt(0)
    v_readfirstlane_b32 s11, v3
    s_cmp_lg_u32 s11, 0
    s_nop 2
    s_cbranch_scc1 L_pf12_ok
    s_sleep 8
    s_add_u32 s15, s15, 1
    s_cmp_lt_u32 s15, 1000000
    s_cbranch_scc1 L_pf12
L_pf12_ok:
    s_mul_i32 s9, s79, 5376
    s_add_u32 s9, s9, 8192
    s_mov_b32 s15, 0
L_poll13:
    buffer_load_dwordx4 v[16:19], v8, s[44:47], s9 offen offset:896 sc1
    buffer_load_dwordx4 v[20:23], v8, s[44:47], s9 offen sc1
    s_add_u32 s15, s15, 1
    s_cmp_lt_u32 s15, 1000000
    s_cselect_b64 s[96:97], -1, 0
    s_waitcnt vmcnt(0)
    v_max_u32 v3, v16, v17
    v_max3_u32 v3, v3, v18, v19
    v_max3_u32 v3, v3, v20, v21
    v_max3_u32 v3, v3, v22, v23
    v_cmp_eq_u32 vcc, -1, v3
    s_and_b64 vcc, vcc, s[96:97]
    s_cbranch_scc1 L_poll13
    v_lshlrev_b32 v240, 16, v16
    v_and_b32 v241, 0xffff0000, v16
    v_lshlrev_b32 v242, 16, v17
    v_and_b32 v243, 0xffff0000, v17
    v_lshlrev_b32 v244, 16, v18
    v_and_b32 v245, 0xffff0000, v18
    v_lshlrev_b32 v246, 16, v19
    v_and_b32 v247, 0xffff0000, v19
    v_lshlrev_b32 v248, 16, v20
    v_and_b32 v249, 0xffff0000, v20
    v_lshlrev_b32 v250, 16, v21
    v_and_b32 v251, 0xffff0000, v21
    v_lshlrev_b32 v252, 16, v22
    v_and_b32 v253, 0xffff0000, v22
    v_lshlrev_b32 v254, 16, v23
    v_and_b32 v255, 0xffff0000, v23
    v_pk_mul_f32 v[224:225], v[224:225], v[240:241]
    v_pk_mul_f32 v[226:227], v[226:227], v[242:243]
    v_pk_mul_f32 v[228:229], v[228:229], v[244:245]
    v_pk_mul_f32 v[230:231], v[230:231], v[246:247]
    v_cvt_pk_bf16_f32 v224, 0, v224
    v_cvt_pk_bf16_f32 v225, 0, v225
    v_cvt_pk_bf16_f32 v226, 0, v226
    v_cvt_pk_bf16_f32 v227, 0, v227
    v_cvt_pk_bf16_f32 v228, 0, v228
    v_cvt_pk_bf16_f32 v229, 0, v229
    v_cvt_pk_bf16_f32 v230, 0, v230
    v_cvt_pk_bf16_f32 v231, 0, v231
    v_pk_add_f32 v[224:225], v[224:225], v[248:249]
    v_pk_add_f32 v[226:227], v[226:227], v[250:251]
    v_pk_add_f32 v[228:229], v[228:229], v[252:253]
    v_pk_add_f32 v[230:231], v[230:231], v[254:255]
    v_cvt_pk_bf16_f32 v16, v224, v225
    v_cvt_pk_bf16_f32 v17, v226, v227
    v_cvt_pk_bf16_f32 v18, v228, v229
    v_cvt_pk_bf16_f32 v19, v230, v231
    s_mul_i32 s8, s79, 1088
    s_add_u32 s8, s8, 147456
    v_add_u32 v7, s8, v7
    ds_write_b128 v7, v[16:19]
    s_waitcnt lgkmcnt(0)
L_sxq:
    v_alignbit_b32 v9, v152, v9, 1
    v_alignbit_b32 v9, v153, v9, 1
    v_alignbit_b32 v9, v154, v9, 1
    v_alignbit_b32 v9, v155, v9, 1
    v_alignbit_b32 v9, v156, v9, 1
    v_alignbit_b32 v9, v157, v9, 1
    v_alignbit_b32 v9, v158, v9, 1
    v_alignbit_b32 v9, v159, v9, 1
    s_lshl_b32 s8, s3, 8
    s_add_u32 s8, s8, 153088
    v_lshl_add_u32 v10, v0, 2, s8
    ds_write_b32 v10, v9
    v_mul_u32_u24 v11, 1088, v6
    v_lshl_add_u32 v11, v1, 4, v11
    v_add_u32 v29, 147456, v11
    v_and_b32 v11, 1, v1
    v_lshl_or_b32 v11, v11, 2, v5
    v_xor_b32 v11, s3, v11
    v_lshlrev_b32 v11, 5, v11
    v_lshl_add_u32 v11, v6, 3, v11
    v_lshl_add_u32 v12, v1, 3, v5
    v_lshl_add_u32 v7, v12, 8, v11
    v_add_u32 v8, 57344, v7
    v_lshlrev_b32 v11, 1, v2
    v_lshl_add_u32 v11, v1, 13, v11
    s_lshl_b32 s8, s4, 8
    s_lshl_b32 s9, s3, 5
    s_add_u32 s8, s8, s9
    s_add_u32 s8, s8, 32768
    s_barrier
    ds_read_b64_tr_b16 v[96:97], v7 offset:0
    ds_read_b64_tr_b16 v[98:99], v7 offset:1024
    ds_read_b128 v[184:187], v29 offset:0
    ds_read_b64_tr_b16 v[100:101], v7 offset:8192
    ds_read_b64_tr_b16 v[102:103], v7 offset:9216
    ds_read_b128 v[188:191], v29 offset:64
    ds_read_b64_tr_b16 v[104:105], v7 offset:16384
    ds_read_b64_tr_b16 v[106:107], v7 offset:17408
    ds_read_b128 v[192:195], v29 offset:128
    ds_read_b64_tr_b16 v[108:109], v7 offset:24576
    ds_read_b64_tr_b16 v[110:111], v7 offset:25600
    ds_read_b128 v[196:199], v29 offset:192
    ds_read_b64_tr_b16 v[112:113], v7 offset:32768
    ds_read_b64_tr_b16 v[114:115], v7 offset:33792
    ds_read_b128 v[200:203], v29 offset:256
    s_waitcnt lgkmcnt(12)
    v_mfma_f32_16x16x32_bf16 v[240:243], v[184:187], v[96:99], 0
    ds_read_b64_tr_b16 v[116:117], v7 offset:40960
    ds_read_b64_tr_b16 v[118:119], v7 offset:41984
    ds_read_b128 v[204:207], v29 offset:320
    s_waitcnt lgkmcnt(12)
    v_mfma_f32_16x16x32_bf16 v[240:243], v[188:191], v[100:103], v[240:243]
    ds_read_b64_tr_b16 v[120:121], v7 offset:49152
    ds_read_b64_tr_b16 v[122:123], v7 offset:50176
    ds_read_b128 v[208:211], v29 offset:384
    s_waitcnt lgkmcnt(12)
    v_mfma_f32_16x16x32_bf16 v[240:243], v[192:195], v[104:107], v[240:243]
    ds_read_b64_tr_b16 v[124:125], v8 offset:0
    ds_read_b64_tr_b16 v[126:127], v8 offset:1024
    ds_read_b128 v[212:215], v29 offset:448
    s_waitcnt lgkmcnt(12)
    v_mfma_f32_16x16x32_bf16 v[240:243], v[196:199], v[108:111], v[240:243]
    ds_read_b64_tr_b16 v[128:129], v8 offset:8192
    ds_read_b64_tr_b16 v[130:131], v8 offset:9216
    ds_read_b128 v[216:219], v29 offset:512
    s_waitcnt lgkmcnt(12)
    v_mfma_f32_16x16x32_bf16 v[240:243], v[200:203], v[112:115], v[240:243]
    ds_read_b64_tr_b16 v[132:133], v8 offset:16384
    ds_read_b64_tr_b16 v[134:135], v8 offset:17408
    ds_read_b128 v[220:223], v29 offset:576
    s_waitcnt lgkmcnt(12)
    v_mfma_f32_16x16x32_bf16 v[240:243], v[204:207], v[116:119], v[240:243]
    ds_read_b64_tr_b16 v[136:137], v8 offset:24576
    ds_read_b64_tr_b16 v[138:139], v8 offset:25600
    ds_read_b128 v[224:227], v29 offset:640
    s_waitcnt lgkmcnt(12)
    v_mfma_f32_16x16x32_bf16 v[240:243], v[208:211], v[120:123], v[240:243]
    ds_read_b64_tr_b16 v[140:141], v8 offset:32768
    ds_read_b64_tr_b16 v[142:143], v8 offset:33792
    ds_read_b128 v[228:231], v29 offset:704
    s_waitcnt lgkmcnt(12)
    v_mfma_f32_16x16x32_bf16 v[240:243], v[212:215], v[124:127], v[240:243]
    ds_read_b64_tr_b16 v[144:145], v8 offset:40960
    ds_read_b64_tr_b16 v[146:147], v8 offset:41984
    ds_read_b128 v[232:235], v29 offset:768
    s_waitcnt lgkmcnt(12)
    v_mfma_f32_16x16x32_bf16 v[240:243], v[216:219], v[128:131], v[240:243]
    ds_read_b64_tr_b16 v[148:149], v8 offset:49152
    ds_read_b64_tr_b16 v[150:151], v8 offset:50176
    ds_read_b128 v[236:239], v29 offset:832
    s_waitcnt lgkmcnt(12)
    v_mfma_f32_16x16x32_bf16 v[240:243], v[220:223], v[132:135], v[240:243]
    s_waitcnt lgkmcnt(9)
    v_mfma_f32_16x16x32_bf16 v[240:243], v[224:227], v[136:139], v[240:243]
    s_waitcnt lgkmcnt(6)
    v_mfma_f32_16x16x32_bf16 v[240:243], v[228:231], v[140:143], v[240:243]
    s_waitcnt lgkmcnt(3)
    v_mfma_f32_16x16x32_bf16 v[240:243], v[232:235], v[144:147], v[240:243]
    s_waitcnt lgkmcnt(0)
    v_mfma_f32_16x16x32_bf16 v[240:243], v[236:239], v[148:151], v[240:243]
    s_nop 7
    v_cndmask_b32 v13, v240, v241, s[66:67]
    v_cndmask_b32 v13, v13, v242, s[68:69]
    v_cndmask_b32 v13, v13, v243, s[70:71]
    v_mul_u32_u24 v14, 320, v1
    v_lshl_add_u32 v15, v2, 1, v14
    s_add_u32 s9, s9, 151808
    v_add_u32 v15, s9, v15
    v_cvt_pk_bf16_f32 v13, v13, v13
    ds_write_b16 v15, v13
    v_lshl_add_u32 v14, v2, 4, v14
    v_add_u32 v14, 151808, v14
    s_waitcnt lgkmcnt(0)
    s_barrier
    s_cmp_lg_u32 s3, 0
    s_cbranch_scc1 L_qf
    ds_read_b128 v[12:15], v14
    v_lshlrev_b32 v11, 4, v2
    v_lshl_add_u32 v11, v1, 13, v11
    s_waitcnt lgkmcnt(0)
    v_min_u32 v12, -2, v12
    v_min_u32 v13, -2, v13
    v_min_u32 v14, -2, v14
    v_min_u32 v15, -2, v15
    buffer_store_dwordx4 v[12:15], v11, s[44:47], s8 offen sc1
L_qf:
    s_cmp_ge_u32 s3, 4
    s_cbranch_scc1 L_sxb1
    s_waitcnt vmcnt(4)
    s_add_u32 s9, s78, 0
    buffer_load_dwordx4 v[32:35], v30, s[60:63], s9 offen offset:0 nt
    s_waitcnt vmcnt(4)
    s_add_u32 s9, s78, 14336
    buffer_load_dwordx4 v[40:43], v31, s[60:63], s9 offen offset:0 nt
    s_waitcnt vmcnt(4)
    s_add_u32 s9, s78, 28672
    buffer_load_dwordx4 v[48:51], v30, s[60:63], s9 offen offset:0 nt
    s_waitcnt vmcnt(4)
    s_add_u32 s9, s78, 43008
    buffer_load_dwordx4 v[56:59], v31, s[60:63], s9 offen offset:0 nt
    s_waitcnt vmcnt(4)
    s_add_u32 s9, s78, 57344
    buffer_load_dwordx4 v[36:39], v30, s[60:63], s9 offen offset:0 nt
    s_waitcnt vmcnt(4)
    s_add_u32 s9, s78, 71680
    buffer_load_dwordx4 v[44:47], v31, s[60:63], s9 offen offset:0 nt
    s_waitcnt vmcnt(4)
    s_add_u32 s9, s78, 86016
    buffer_load_dwordx4 v[52:55], v30, s[60:63], s9 offen offset:0 nt
    s_waitcnt vmcnt(4)
    s_add_u32 s9, s78, 100352
    buffer_load_dwordx4 v[60:63], v31, s[60:63], s9 offen offset:0 nt
    s_waitcnt vmcnt(4)
    s_add_u32 s9, s78, 0
    buffer_load_dwordx4 v[64:67], v30, s[60:63], s9 offen offset:896 nt
    s_waitcnt vmcnt(4)
    s_add_u32 s9, s78, 14336
    buffer_load_dwordx4 v[72:75], v31, s[60:63], s9 offen offset:896 nt
    s_waitcnt vmcnt(4)
    s_add_u32 s9, s78, 28672
    buffer_load_dwordx4 v[80:83], v30, s[60:63], s9 offen offset:896 nt
    s_waitcnt vmcnt(4)
    s_add_u32 s9, s78, 43008
    buffer_load_dwordx4 v[88:91], v31, s[60:63], s9 offen offset:896 nt
    s_waitcnt vmcnt(4)
    s_add_u32 s9, s78, 57344
    buffer_load_dwordx4 v[68:71], v30, s[60:63], s9 offen offset:896 nt
    s_waitcnt vmcnt(4)
    s_add_u32 s9, s78, 71680
    buffer_load_dwordx4 v[76:79], v31, s[60:63], s9 offen offset:896 nt
    s_waitcnt vmcnt(4)
    s_add_u32 s9, s78, 86016
    buffer_load_dwordx4 v[84:87], v30, s[60:63], s9 offen offset:896 nt
    s_waitcnt vmcnt(4)
    s_add_u32 s9, s78, 100352
    buffer_load_dwordx4 v[92:95], v31, s[60:63], s9 offen offset:896 nt
L_sxb1:
    s_cmp_lg_u32 s3, 7
    s_cbranch_scc1 L_sxb2
    s_mov_b32 s15, 0
L_pf14:
    buffer_load_dword v3, off, s[48:51], 0 offset:8 sc1
    s_waitcnt vmcnt(0)
    v_readfirstlane_b32 s11, v3
    s_cmp_lg_u32 s11, 0
    s_nop 2
    s_cbranch_scc1 L_pf14_ok
    s_sleep 8
    s_add_u32 s15, s15, 1
    s_cmp_lt_u32 s15, 1000000
    s_cbranch_scc1 L_pf14
L_pf14_ok:
    s_sub_u32 s98, s11, 1
    v_mov_b32 v12, -1
    v_mov_b32 v13, -1
    v_mov_b32 v14, -1
    v_mov_b32 v15, -1
    v_lshlrev_b32 v11, 4, v0
    s_cmp_ge_u32 s4, 28
    s_cbranch_scc1 L_sxr1
    s_lshl_b32 s8, s4, 13
    s_add_u32 s8, s8, 655360
    s_add_u32 s9, s8, 4096
    s_cmp_lg_u32 s98, 1
    s_cbranch_scc1 L_hs15a
    buffer_store_dwordx4 v[12:15], v11, s[44:47], s8 offen offset:0
    buffer_store_dwordx4 v[12:15], v11, s[44:47], s8 offen offset:1024
    buffer_store_dwordx4 v[12:15], v11, s[44:47], s8 offen offset:2048
    buffer_store_dwordx4 v[12:15], v11, s[44:47], s8 offen offset:3072
    buffer_store_dwordx4 v[12:15], v11, s[44:47], s9 offen offset:0
    buffer_store_dwordx4 v[12:15], v11, s[44:47], s9 offen offset:1024
    buffer_store_dwordx4 v[12:15], v11, s[44:47], s9 offen offset:2048
    buffer_store_dwordx4 v[12:15], v11, s[44:47], s9 offen offset:3072
L_hs15b:
    s_nop 0
    s_branch L_sxr2
L_sxr1:
    s_lshl_b32 s8, s4, 10
    s_add_u32 s8, s8, 1089536
    s_cmp_lg_u32 s98, 1
    s_cbranch_scc1 L_hs16a
    buffer_store_dwordx4 v[12:15], v11, s[44:47], s8 offen
L_hs16b:
L_sxr2:
    s_waitcnt vmcnt(0)
    s_mov_b32 s9, 1
    s_atomic_add s9, s[40:41], 128 glc
    s_waitcnt lgkmcnt(0)
    s_cmp_lg_u32 s9, 31
    s_cbranch_scc1 L_ar17
    s_mov_b64 exec, 1
    v_mov_b32 v16, 1
    buffer_store_dword v16, off, s[48:51], 0 offset:4 sc1
    s_mov_b64 exec, -1
L_ar17:
L_sxb2:
    s_mov_b32 s52, s32
    s_mov_b32 s53, s33
    s_mov_b32 s54, 1605632
    s_mov_b32 s55, 0x20000
    s_mov_b32 s56, s28
    s_mov_b32 s57, s29
    s_mov_b32 s58, 1605632
    s_mov_b32 s59, 0x20000
    s_lshl_b32 s8, s3, 12
    s_add_u32 s8, s8, 114688
    v_lshl_add_u32 v16, v0, 4, s8
    v_lshl_add_u32 v12, v1, 3, v5
    v_lshlrev_b32 v12, 7, v12
    v_lshrrev_b32 v13, 1, v5
    v_and_b32 v14, 1, v1
    v_lshl_or_b32 v13, v14, 1, v13
    v_lshlrev_b32 v14, 3, v6
    v_lshl_add_u32 v14, v13, 5, v14
    v_add3_u32 v17, v12, v14, s8
    v_xor_b32 v18, 32, v17
    v_xor_b32 v19, 64, v17
    v_xor_b32 v20, 96, v17
    v_lshrrev_b32 v14, 1, v6
    v_lshl_or_b32 v13, v14, 2, v13
    v_xor_b32 v13, s3, v13
    v_lshl_add_u32 v13, v13, 4, v12
    v_mul_u32_u24 v14, 57344, v14
    v_and_b32 v15, 1, v6
    v_lshlrev_b32 v15, 3, v15
    v_add3_u32 v4, v13, v14, v15
    s_cmp_ge_u32 s4, 28
    s_cselect_b32 s10, 1073741824, 0
    s_cmp_eq_u32 s3, 7
    s_cselect_b32 s9, 1073741824, s10
    v_lshrrev_b32 v11, 3, v0
    v_mul_u32_u24 v12, 896, v11
    v_add3_u32 v22, v12, v28, s9
    v_xor_b32 v23, 64, v22
    v_mul_u32_u24 v12, 3584, v11
    v_and_b32 v13, 7, v0
    v_bfe_u32 v14, v0, 4, 1
    v_xor_b32 v13, v13, v14
    v_lshlrev_b32 v13, 4, v13
    v_add3_u32 v24, v12, v13, s10
    v_xor_b32 v25, 64, v24
    v_xor_b32 v26, 32, v24
    v_xor_b32 v27, 96, v24
    s_mov_b32 s8, 100925952
    s_mov_b32 s9, 0
    s_cmp_ge_u32 s3, 4
    s_cselect_b32 s8, 420744712, s8
    s_cselect_b32 s9, 16974852, s9
    s_lshl_b32 s11, s79, 3
    s_lshr_b32 s8, s8, s11
    s_and_b32 s8, s8, 255
    s_lshr_b32 s75, s9, s11
    s_and_b32 s75, s75, 255
    s_mul_i32 s72, s4, 57344
    s_lshl_b32 s9, s3, 7
    s_add_u32 s72, s72, s9
    s_mul_i32 s73, s8, 57344
    s_lshl_b32 s9, s4, 7
    s_add_u32 s73, s73, s9
    s_lshl_b32 s74, s8, 11
    s_waitcnt vmcnt(4)
    buffer_load_dwordx4 v[152:155], v22, s[52:55], s72 offen nt
    s_add_u32 s72, s72, 7168
    s_waitcnt vmcnt(13)
    ds_write_b128 v16, v[32:35] offset:0
    ds_write_b128 v16, v[40:43] offset:1024
    ds_write_b128 v16, v[48:51] offset:2048
    ds_write_b128 v16, v[56:59] offset:3072
    s_waitcnt lgkmcnt(0)
    ds_read_b64_tr_b16 v[32:33], v17 offset:0
    ds_read_b64_tr_b16 v[34:35], v17 offset:512
    ds_read_b64_tr_b16 v[40:41], v18 offset:0
    ds_read_b64_tr_b16 v[42:43], v18 offset:512
    ds_read_b64_tr_b16 v[48:49], v19 offset:0
    ds_read_b64_tr_b16 v[50:51], v19 offset:512
    ds_read_b64_tr_b16 v[56:57], v20 offset:0
    ds_read_b64_tr_b16 v[58:59], v20 offset:512
    s_waitcnt lgkmcnt(0)
    s_waitcnt vmcnt(9)
    ds_write_b128 v16, v[36:39] offset:0
    ds_write_b128 v16, v[44:47] offset:1024
    ds_write_b128 v16, v[52:55] offset:2048
    ds_write_b128 v16, v[60:63] offset:3072
    s_waitcnt lgkmcnt(0)
    ds_read_b64_tr_b16 v[36:37], v17 offset:0
    ds_read_b64_tr_b16 v[38:39], v17 offset:512
    ds_read_b64_tr_b16 v[44:45], v18 offset:0
    ds_read_b64_tr_b16 v[46:47], v18 offset:512
    ds_read_b64_tr_b16 v[52:53], v19 offset:0
    ds_read_b64_tr_b16 v[54:55], v19 offset:512
    ds_read_b64_tr_b16 v[60:61], v20 offset:0
    ds_read_b64_tr_b16 v[62:63], v20 offset:512
    s_waitcnt lgkmcnt(0)
    s_waitcnt vmcnt(5)
    ds_write_b128 v16, v[64:67] offset:0
    ds_write_b128 v16, v[72:75] offset:1024
    ds_write_b128 v16, v[80:83] offset:2048
    ds_write_b128 v16, v[88:91] offset:3072
    s_waitcnt lgkmcnt(0)
    ds_read_b64_tr_b16 v[64:65], v17 offset:0
    ds_read_b64_tr_b16 v[66:67], v17 offset:512
    ds_read_b64_tr_b16 v[72:73], v18 offset:0
    ds_read_b64_tr_b16 v[74:75], v18 offset:512
    ds_read_b64_tr_b16 v[80:81], v19 offset:0
    ds_read_b64_tr_b16 v[82:83], v19 offset:512
    ds_read_b64_tr_b16 v[88:89], v20 offset:0
    ds_read_b64_tr_b16 v[90:91], v20 offset:512
    s_waitcnt lgkmcnt(0)
    s_waitcnt vmcnt(4)
    buffer_load_dwordx4 v[160:163], v23, s[52:55], s72 offen nt
    s_add_u32 s72, s72, 7168
    s_waitcnt vmcnt(4)
    buffer_load_dwordx4 v[168:171], v22, s[52:55], s72 offen nt
    s_add_u32 s72, s72, 7168
    s_waitcnt vmcnt(4)
    buffer_load_dwordx4 v[176:179], v23, s[52:55], s72 offen nt
    s_add_u32 s72, s72, 7168
    s_waitcnt vmcnt(4)
    buffer_load_dwordx4 v[156:159], v22, s[52:55], s72 offen nt
    s_add_u32 s72, s72, 7168
    s_waitcnt vmcnt(5)
    ds_write_b128 v16, v[68:71] offset:0
    ds_write_b128 v16, v[76:79] offset:1024
    ds_write_b128 v16, v[84:87] offset:2048
    ds_write_b128 v16, v[92:95] offset:3072
    s_waitcnt lgkmcnt(0)
    ds_read_b64_tr_b16 v[68:69], v17 offset:0
    ds_read_b64_tr_b16 v[70:71], v17 offset:512
    ds_read_b64_tr_b16 v[76:77], v18 offset:0
    ds_read_b64_tr_b16 v[78:79], v18 offset:512
    ds_read_b64_tr_b16 v[84:85], v19 offset:0
    ds_read_b64_tr_b16 v[86:87], v19 offset:512
    ds_read_b64_tr_b16 v[92:93], v20 offset:0
    ds_read_b64_tr_b16 v[94:95], v20 offset:512
    s_waitcnt lgkmcnt(0)
    s_waitcnt vmcnt(4)
    buffer_load_dwordx4 v[164:167], v23, s[52:55], s72 offen nt
    s_add_u32 s72, s72, 7168
    s_waitcnt vmcnt(4)
    buffer_load_dwordx4 v[172:175], v22, s[52:55], s72 offen nt
    s_add_u32 s72, s72, 7168
    s_waitcnt vmcnt(4)
    buffer_load_dwordx4 v[180:183], v23, s[52:55], s72 offen nt
    s_add_u32 s72, s72, 7168
    s_waitcnt vmcnt(4)
    s_mov_b32 s60, s30
    s_mov_b32 s61, s31
    s_mov_b32 s62, 1605632
    s_mov_b32 s63, 0x20000
    s_add_u32 m0, s74, 0
    s_nop 0
    buffer_load_dwordx4 v24, s[56:59], s73 offen nt lds
    s_waitcnt vmcnt(5)
    ds_write_b128 v16, v[152:155] offset:0
    ds_write_b128 v16, v[160:163] offset:1024
    ds_write_b128 v16, v[168:171] offset:2048
    ds_write_b128 v16, v[176:179] offset:3072
    s_waitcnt lgkmcnt(0)
    ds_read_b64_tr_b16 v[152:153], v17 offset:0
    ds_read_b64_tr_b16 v[154:155], v17 offset:512
    ds_read_b64_tr_b16 v[160:161], v18 offset:0
    ds_read_b64_tr_b16 v[162:163], v18 offset:512
    ds_read_b64_tr_b16 v[168:169], v19 offset:0
    ds_read_b64_tr_b16 v[170:171], v19 offset:512
    ds_read_b64_tr_b16 v[176:177], v20 offset:0
    ds_read_b64_tr_b16 v[178:179], v20 offset:512
    s_waitcnt lgkmcnt(0)
    s_waitcnt vmcnt(4)
    s_add_u32 m0, s74, 57344
    s_nop 0
    buffer_load_dwordx4 v25, s[60:63], s73 offen nt lds
    s_add_u32 s73, s73, 28672
    s_waitcnt vmcnt(4)
    s_add_u32 m0, s74, 1024
    s_nop 0
    buffer_load_dwordx4 v26, s[56:59], s73 offen nt lds
    s_waitcnt vmcnt(4)
    s_add_u32 m0, s74, 58368
    s_nop 0
    buffer_load_dwordx4 v27, s[60:63], s73 offen nt lds
    s_add_u32 s73, s73, 28672
    s_waitcnt vmcnt(4)
    s_add_u32 m0, s74, 2048
    s_nop 0
    buffer_load_dwordx4 v24, s[56:59], s73 offen nt lds
    s_waitcnt vmcnt(5)
    ds_write_b128 v16, v[156:159] offset:0
    ds_write_b128 v16, v[164:167] offset:1024
    ds_write_b128 v16, v[172:175] offset:2048
    ds_write_b128 v16, v[180:183] offset:3072
    s_waitcnt lgkmcnt(0)
    ds_read_b64_tr_b16 v[156:157], v17 offset:0
    ds_read_b64_tr_b16 v[158:159], v17 offset:512
    ds_read_b64_tr_b16 v[164:165], v18 offset:0
    ds_read_b64_tr_b16 v[166:167], v18 offset:512
    ds_read_b64_tr_b16 v[172:173], v19 offset:0
    ds_read_b64_tr_b16 v[174:175], v19 offset:512
    ds_read_b64_tr_b16 v[180:181], v20 offset:0
    ds_read_b64_tr_b16 v[182:183], v20 offset:512
    s_waitcnt lgkmcnt(0)
    s_waitcnt vmcnt(4)
    s_add_u32 m0, s74, 59392
    s_nop 0
    buffer_load_dwordx4 v25, s[60:63], s73 offen nt lds
    s_add_u32 s73, s73, 28672
    s_waitcnt vmcnt(4)
    s_add_u32 m0, s74, 3072
    s_nop 0
    buffer_load_dwordx4 v26, s[56:59], s73 offen nt lds
    s_waitcnt vmcnt(4)
    s_add_u32 m0, s74, 60416
    s_nop 0
    buffer_load_dwordx4 v27, s[60:63], s73 offen nt lds
    s_add_u32 s73, s73, 28672
    s_add_u32 s74, s74, 4096
L_gul:
    s_cmp_eq_u32 s75, 0
    s_cbranch_scc1 L_gue
    s_waitcnt vmcnt(4)
    s_add_u32 m0, s74, 0
    s_nop 0
    buffer_load_dwordx4 v24, s[56:59], s73 offen nt lds
    s_waitcnt vmcnt(4)
    s_add_u32 m0, s74, 57344
    s_nop 0
    buffer_load_dwordx4 v25, s[60:63], s73 offen nt lds
    s_add_u32 s73, s73, 28672
    s_waitcnt vmcnt(4)
    s_add_u32 m0, s74, 1024
    s_nop 0
    buffer_load_dwordx4 v26, s[56:59], s73 offen nt lds
    s_waitcnt vmcnt(4)
    s_add_u32 m0, s74, 58368
    s_nop 0
    buffer_load_dwordx4 v27, s[60:63], s73 offen nt lds
    s_add_u32 s73, s73, 28672
    s_add_u32 s74, s74, 2048
    s_sub_u32 s75, s75, 1
    s_branch L_gul
L_gue:
    buffer_load_dwordx2 v[232:233], off, s[48:51], 0 offset:4 sc1
    v_mov_b32 v12, 1073741824
    v_lshlrev_b32 v24, 4, v0
    v_cndmask_b32 v22, v12, v24, s[64:65]
    s_mul_i32 s8, s79, 1088
    s_add_u32 s8, s8, 147456
    v_lshrrev_b32 v13, 1, v0
    v_lshlrev_b32 v13, 5, v13
    v_and_b32 v14, 1, v0
    v_lshl_add_u32 v13, v14, 3, v13
    v_add_u32 v23, s8, v13
    s_mov_b32 s52, s16
    s_mov_b32 s53, s17
    s_mov_b32 s54, 3584
    s_mov_b32 s55, 0x20000
    s_mov_b32 s56, s38
    s_mov_b32 s57, s39
    s_mov_b32 s58, 3584
    s_mov_b32 s59, 0x20000
    s_cmp_ge_u32 s4, 28
    s_cbranch_scc1 L_sxp2
    v_mov_b32 v30, v22
    s_cmp_ge_u32 s3, 4
    s_cbranch_scc1 L_sxp1
    s_mul_i32 s9, s79, 5376
    s_add_u32 s9, s9, 8192
    s_mov_b32 s15, 0
    s_branch L_poll18_f
L_poll18:
    s_sleep 8
L_poll18_f:
    buffer_load_dwordx4 v[8:11], v22, s[44:47], s9 offen offset:3584 sc1
    buffer_load_dwordx4 v[12:15], v22, s[44:47], s9 offen offset:2688 sc1
    s_add_u32 s15, s15, 1
    s_cmp_lt_u32 s15, 1000000
    s_cselect_b64 s[96:97], -1, 0
    s_waitcnt vmcnt(0)
    v_max_u32 v3, v8, v9
    v_max3_u32 v3, v3, v10, v11
    v_max3_u32 v3, v3, v12, v13
    v_max3_u32 v3, v3, v14, v15
    v_cmp_eq_u32 vcc, -1, v3
    s_and_b64 vcc, vcc, s[96:97]
    s_cbranch_scc1 L_poll18
    v_lshlrev_b32 v240, 16, v8
    v_and_b32 v241, 0xffff0000, v8
    v_lshlrev_b32 v242, 16, v9
    v_and_b32 v243, 0xffff0000, v9
    v_lshlrev_b32 v244, 16, v10
    v_and_b32 v245, 0xffff0000, v10
    v_lshlrev_b32 v246, 16, v11
    v_and_b32 v247, 0xffff0000, v11
    v_lshlrev_b32 v248, 16, v12
    v_and_b32 v249, 0xffff0000, v12
    v_lshlrev_b32 v250, 16, v13
    v_and_b32 v251, 0xffff0000, v13
    v_lshlrev_b32 v252, 16, v14
    v_and_b32 v253, 0xffff0000, v14
    v_lshlrev_b32 v254, 16, v15
    v_and_b32 v255, 0xffff0000, v15
L_sxp1:
    s_cmp_lg_u32 s3, 7
    s_cbranch_scc1 L_sxp2
    v_and_b32 v11, 14, v2
    v_lshlrev_b32 v11, 1, v11
    v_mul_u32_u24 v13, 5376, v1
    v_add_u32 v13, v13, v11
    v_mul_u32_u24 v14, 896, v1
    v_add_u32 v14, v14, v11
    s_lshl_b32 s8, s4, 5
    s_add_u32 s9, s8, 12672
    s_add_u32 s10, s8, 9984
    buffer_load_dword v10, v14, s[52:55], s8 offen
    s_mov_b32 s15, 0
    s_branch L_poll19_f
L_poll19:
    s_sleep 8
L_poll19_f:
    buffer_load_dword v8, v13, s[44:47], s10 offen sc1
    buffer_load_dword v9, v13, s[44:47], s9 offen sc1
    s_add_u32 s15, s15, 1
    s_cmp_lt_u32 s15, 1000000
    s_cselect_b64 s[96:97], -1, 0
    s_waitcnt vmcnt(0)
    v_max_u32 v3, v8, v9
    v_cmp_eq_u32 vcc, -1, v3
    s_and_b64 vcc, vcc, s[96:97]
    s_cbranch_scc1 L_poll19
    v_and_b32 v11, 1, v2
    v_lshlrev_b32 v11, 4, v11
    v_lshrrev_b32 v240, v11, v8
    v_lshlrev_b32 v240, 16, v240
    v_lshrrev_b32 v242, v11, v9
    v_lshlrev_b32 v242, 16, v242
    v_lshrrev_b32 v241, v11, v10
    v_lshlrev_b32 v241, 16, v241
L_sxp2:
    s_waitcnt vmcnt(0)
    v_readfirstlane_b32 s8, v232
    v_readfirstlane_b32 s98, v233
    s_sub_u32 s98, s98, 1
    s_cmp_lg_u32 s8, 0
    s_nop 1
    s_cbranch_scc1 L_sxp3
    s_mov_b32 s15, 0
L_pf20:
    buffer_load_dword v3, off, s[48:51], 0 offset:4 sc1
    s_waitcnt vmcnt(0)
    v_readfirstlane_b32 s11, v3
    s_cmp_lg_u32 s11, 0
    s_nop 2
    s_cbranch_scc1 L_pf20_ok
    s_sleep 8
    s_add_u32 s15, s15, 1
    s_cmp_lt_u32 s15, 1000000
    s_cbranch_scc1 L_pf20
L_pf20_ok:
    s_mov_b32 s15, 0
L_pf21:
    buffer_load_dword v3, off, s[48:51], 0 offset:8 sc1
    s_waitcnt vmcnt(0)
    v_readfirstlane_b32 s11, v3
    s_cmp_lg_u32 s11, 0
    s_nop 2
    s_cbranch_scc1 L_pf21_ok
    s_sleep 8
    s_add_u32 s15, s15, 1
    s_cmp_lt_u32 s15, 1000000
    s_cbranch_scc1 L_pf21
L_pf21_ok:
    s_sub_u32 s98, s11, 1
L_sxp3:
    s_barrier
    ds_read_b64_tr_b16 v[96:97], v4 offset:0
    ds_read_b64_tr_b16 v[98:99], v4 offset:512
    ds_read_b64_tr_b16 v[100:101], v4 offset:4096
    ds_read_b64_tr_b16 v[102:103], v4 offset:4608
    ds_read_b64_tr_b16 v[104:105], v4 offset:8192
    ds_read_b64_tr_b16 v[106:107], v4 offset:8704
    ds_read_b64_tr_b16 v[108:109], v4 offset:12288
    ds_read_b64_tr_b16 v[110:111], v4 offset:12800
    ds_read_b64_tr_b16 v[112:113], v4 offset:16384
    ds_read_b64_tr_b16 v[114:115], v4 offset:16896
    ds_read_b64_tr_b16 v[116:117], v4 offset:20480
    ds_read_b64_tr_b16 v[118:119], v4 offset:20992
    ds_read_b64_tr_b16 v[120:121], v4 offset:24576
    ds_read_b64_tr_b16 v[122:123], v4 offset:25088
    s_waitcnt lgkmcnt(0)
    ds_read_b64_tr_b16 v[124:125], v4 offset:28672
    ds_read_b64_tr_b16 v[126:127], v4 offset:29184
    ds_read_b64_tr_b16 v[128:129], v4 offset:32768
    ds_read_b64_tr_b16 v[130:131], v4 offset:33280
    ds_read_b64_tr_b16 v[132:133], v4 offset:36864
    ds_read_b64_tr_b16 v[134:135], v4 offset:37376
    ds_read_b64_tr_b16 v[136:137], v4 offset:40960
    ds_read_b64_tr_b16 v[138:139], v4 offset:41472
    ds_read_b64_tr_b16 v[140:141], v4 offset:45056
    ds_read_b64_tr_b16 v[142:143], v4 offset:45568
    ds_read_b64_tr_b16 v[144:145], v4 offset:49152
    ds_read_b64_tr_b16 v[146:147], v4 offset:49664
    ds_read_b64_tr_b16 v[148:149], v4 offset:53248
    ds_read_b64_tr_b16 v[150:151], v4 offset:53760
    s_lshl_b32 s8, s3, 8
    s_add_u32 s8, s8, 153088
    v_lshl_add_u32 v10, v0, 2, s8
    ds_read_b32 v9, v10
    v_mov_b32 v12, 1073741824
    v_lshlrev_b32 v11, 4, v2
    v_lshl_add_u32 v16, v1, 9, v11
    v_add_u32 v13, 2048, v16
    v_cndmask_b32 v17, v13, v12, s[70:71]
    s_lshr_b32 s8, s3, 1
    s_and_b32 s9, s3, 1
    s_lshl_b32 s72, s4, 14
    s_lshl_b32 s10, s8, 12
    s_add_u32 s72, s72, s10
    s_lshl_b32 s10, s9, 8
    s_add_u32 s72, s72, s10
    s_add_u32 s72, s72, 131072
    v_lshlrev_b32 v18, 7, v1
    v_add_u32 v13, 512, v18
    v_cndmask_b32 v19, v13, v12, s[70:71]
    s_waitcnt lgkmcnt(0)
    v_not_b32 v9, v9
    v_and_b32 v10, 0x0fffffff, v9
    v_cndmask_b32 v9, v9, v10, s[70:71]
    v_bfe_u32 v216, v9, 24, 1
    v_bfe_u32 v217, v9, 25, 1
    v_bfe_u32 v218, v9, 26, 1
    v_bfe_u32 v219, v9, 27, 1
    v_bfe_u32 v220, v9, 28, 1
    v_bfe_u32 v221, v9, 29, 1
    v_bfe_u32 v222, v9, 30, 1
    v_bfe_u32 v223, v9, 31, 1
    s_lshr_b32 s73, s4, 2
    s_lshl_b32 s73, s73, 12
    s_lshl_b32 s10, s8, 10
    s_add_u32 s73, s73, s10
    s_add_u32 s73, s73, 1085440
    s_mul_i32 s10, s8, 320
    s_lshl_b32 s11, s9, 7
    s_add_u32 s10, s10, s11
    s_add_u32 s10, s10, 151808
    v_lshrrev_b32 v14, 1, v1
    v_and_b32 v15, 1, v1
    v_lshlrev_b32 v13, 5, v5
    v_lshl_add_u32 v13, v14, 4, v13
    v_lshl_add_u32 v13, v6, 2, v13
    v_lshl_add_u32 v13, v15, 1, v13
    v_add_u32 v20, s10, v13
    v_lshl_add_u32 v14, v15, 1, v14
    v_bfe_u32 v8, v2, 1, 1
    v_bfe_u32 v9, v2, 2, 1
    v_and_b32 v10, 1, v2
    v_mul_u32_u24 v13, 320, v14
    v_lshl_add_u32 v13, v8, 4, v13
    v_lshl_add_u32 v13, v9, 2, v13
    v_lshl_add_u32 v13, v10, 1, v13
    s_lshr_b32 s10, s3, 1
    s_lshl_b32 s10, s10, 5
    s_and_b32 s11, s3, 1
    s_lshl_b32 s11, s11, 3
    s_add_u32 s10, s10, s11
    s_add_u32 s10, s10, 151808
    v_add_u32 v27, s10, v13
    v_lshl_add_u32 v9, v9, 1, v10
    v_lshlrev_b32 v10, 5, v1
    v_lshl_add_u32 v10, v8, 4, v10
    v_mul_u32_u24 v13, 320, v9
    v_add_u32 v13, v13, v10
    v_add_u32 v21, 151808, v13
    v_mul_u32_u24 v13, 1088, v9
    v_add_u32 v13, v13, v10
    v_add_u32 v29, 147456, v13
    v_mul_u32_u24 v13, 0xaaaa, v8
    v_add_u32 v31, 0x4444, v13
    v_lshl_add_u32 v28, v1, 13, v11
    v_mov_b32 v224, 0
    v_mov_b32 v225, 0
    v_mov_b32 v226, 0
    v_mov_b32 v227, 0
    v_mov_b32 v228, 0
    v_mov_b32 v229, 0
    v_mov_b32 v230, 0
    v_mov_b32 v231, 0
    v_mov_b32 v232, 0
    v_mov_b32 v233, 0
    v_mov_b32 v234, 0
    v_mov_b32 v235, 0
    v_mov_b32 v236, 0
    v_mov_b32 v237, 0
    v_mov_b32 v238, 0
    v_mov_b32 v239, 0
    s_lshl_b32 s74, s3, 15
    s_lshl_b32 s10, s4, 8
    s_add_u32 s74, s74, s10
    s_add_u32 s74, s74, 655360
    s_lshl_b32 s75, s4, 13
    s_add_u32 s75, s75, 655360
    s_lshl_b32 s76, s79, 10
    s_add_u32 s76, s76, 1118208
    s_lshl_b32 s77, s4, 5
    s_add_u32 s77, s77, 1118208
    v_lshlrev_b32 v13, 1, v2
    v_lshl_add_u32 v25, v1, 10, v13
    v_mul_u32_u24 v13, 896, v1
    v_lshl_add_u32 v26, v2, 1, v13
    s_cmp_ge_u32 s4, 28
    s_cbranch_scc1 L_tch
    s_cmp_lg_u32 s3, 7
    s_cbranch_scc1 L_tch
    v_lshlrev_b32 v13, 7, v0
    v_cndmask_b32 v14, v12, v13, s[64:65]
    s_mov_b32 s8, 1118208
    v_and_b32 v15, 0xfff, v13
    buffer_load_dword v8, v13, s[44:47], s75 offen sc1
    buffer_load_dword v10, v15, s[44:47], s8 offen sc1
L_tch:
    s_waitcnt lgkmcnt(0)
    s_mov_b32 s15, 0
    s_branch L_poll22_f
L_poll22:
    s_sleep 2
L_poll22_f:
    buffer_load_dwordx4 v[184:187], v18, s[44:47], s73 offen sc1
    buffer_load_dwordx4 v[188:191], v19, s[44:47], s73 offen sc1
    s_add_u32 s15, s15, 1
    s_cmp_lt_u32 s15, 1000000
    s_cselect_b64 s[96:97], -1, 0
    s_waitcnt vmcnt(0)
    v_max_u32 v3, v184, v185
    v_max3_u32 v3, v3, v186, v187
    v_max3_u32 v3, v3, v188, v189
    v_max3_u32 v3, v3, v190, v191
    v_cmp_eq_u32 vcc, -1, v3
    s_and_b64 vcc, vcc, s[96:97]
    s_cbranch_scc1 L_poll22
    s_mov_b32 s8, 0
    buffer_load_dwordx4 v[192:195], v16, s[44:47], s72 offen sc1
    buffer_load_dwordx4 v[196:199], v17, s[44:47], s72 offen sc1
L_h1s:
    v_cndmask_b32 v188, v188, v184, s[70:71]
    v_cndmask_b32 v190, v190, v186, s[70:71]
    v_max_f32 v200, v184, v188
    v_max_f32 v201, v186, v190
    v_mov_b32 v202, v200
    v_mov_b32 v203, v201
    s_nop 0
    v_permlane32_swap_b32 v200, v202
    v_permlane32_swap_b32 v201, v203
    v_max_f32 v200, v200, v202
    v_max_f32 v201, v201, v203
    v_mov_b32 v202, v200
    v_mov_b32 v203, v201
    s_nop 0
    v_permlane16_swap_b32 v200, v202
    v_permlane16_swap_b32 v201, v203
    v_max_f32 v200, v200, v202
    v_max_f32 v201, v201, v203
    v_sub_f32 v184, v184, v200
    v_sub_f32 v186, v186, v201
    v_sub_f32 v188, v188, v200
    v_sub_f32 v190, v190, v201
    v_mul_f32 v184, s14, v184
    v_mul_f32 v186, s14, v186
    v_mul_f32 v188, s14, v188
    v_mul_f32 v190, s14, v190
    v_exp_f32 v184, v184
    v_exp_f32 v186, v186
    v_exp_f32 v188, v188
    v_exp_f32 v190, v190
    v_mul_f32 v200, v185, v184
    v_mul_f32 v201, v187, v186
    v_fmac_f32 v200, v189, v188
    v_fmac_f32 v201, v191, v190
    v_mov_b32 v202, v200
    v_mov_b32 v203, v201
    s_nop 0
    v_permlane32_swap_b32 v200, v202
    v_permlane32_swap_b32 v201, v203
    v_add_f32 v200, v200, v202
    v_add_f32 v201, v201, v203
    v_mov_b32 v202, v200
    v_mov_b32 v203, v201
    s_nop 0
    v_permlane16_swap_b32 v200, v202
    v_permlane16_swap_b32 v201, v203
    v_add_f32 v200, v200, v202
    v_add_f32 v201, v201, v203
    v_rcp_f32 v200, v200
    v_rcp_f32 v201, v201
    v_mul_f32 v204, v184, v200
    v_mul_f32 v205, v186, v201
    v_mul_f32 v206, v188, v200
    v_mul_f32 v207, v190, v201
    s_mov_b32 s15, 0
    s_branch L_h1w
L_h1l:
    buffer_load_dwordx4 v[192:195], v16, s[44:47], s72 offen sc1
    buffer_load_dwordx4 v[196:199], v17, s[44:47], s72 offen sc1
L_h1w:
    s_add_u32 s15, s15, 1
    s_cmp_lt_u32 s15, 1000000
    s_cselect_b64 s[96:97], -1, 0
    s_waitcnt vmcnt(0)
    v_xor_b32 v192, v192, v216
    v_xor_b32 v193, v193, v217
    v_xor_b32 v194, v194, v218
    v_xor_b32 v195, v195, v219
    v_xor_b32 v196, v196, v220
    v_xor_b32 v197, v197, v221
    v_xor_b32 v198, v198, v222
    v_xor_b32 v199, v199, v223
    v_or3_b32 v3, v192, v193, v194
    v_or3_b32 v8, v195, v196, v197
    v_or3_b32 v3, v3, v198, v199
    v_or_b32 v3, v3, v8
    v_and_b32 v3, 1, v3
    v_cmp_ne_u32 vcc, 0, v3
    s_and_b64 vcc, vcc, s[96:97]
    s_cbranch_scc1 L_h1l
    v_pk_mul_f32 v[208:209], v[192:193], v[204:205]
    v_pk_mul_f32 v[210:211], v[194:195], v[204:205]
    v_pk_fma_f32 v[208:209], v[196:197], v[206:207], v[208:209]
    v_pk_fma_f32 v[210:211], v[198:199], v[206:207], v[210:211]
    s_nop 1
    v_permlane32_swap_b32 v208, v210
    v_permlane32_swap_b32 v209, v211
    v_pk_add_f32 v[208:209], v[208:209], v[210:211]
    s_nop 1
    v_permlane16_swap_b32 v208, v209
    v_add_f32 v208, v208, v209
    v_cvt_pk_bf16_f32 v208, v208, v208
    ds_write_b16 v20, v208
    s_waitcnt lgkmcnt(0)
    s_barrier
    s_cmp_eq_u32 s3, 7
    s_cbranch_scc1 L_rstage
    ds_read_b128 v[184:187], v21 offset:0
    ds_read_b128 v[188:191], v21 offset:128
    s_waitcnt lgkmcnt(1)
    v_smfmac_f32_16x16x64_bf16 v[224:227], v[184:187], v[32:39], v31
    v_smfmac_f32_16x16x64_bf16 v[228:231], v[184:187], v[40:47], v31
    v_smfmac_f32_16x16x64_bf16 v[232:235], v[184:187], v[48:55], v31
    v_smfmac_f32_16x16x64_bf16 v[236:239], v[184:187], v[56:63], v31
    s_waitcnt lgkmcnt(0)
    v_smfmac_f32_16x16x64_bf16 v[224:227], v[188:191], v[64:71], v31
    v_smfmac_f32_16x16x64_bf16 v[228:231], v[188:191], v[72:79], v31
    v_smfmac_f32_16x16x64_bf16 v[232:235], v[188:191], v[80:87], v31
    v_smfmac_f32_16x16x64_bf16 v[236:239], v[188:191], v[88:95], v31
    s_nop 4
    v_pk_add_f32 v[192:193], v[224:225], v[226:227]
    v_pk_add_f32 v[194:195], v[228:229], v[230:231]
    s_mov_b32 exec_lo, 0
    v_pk_add_f32 v[192:193], v[232:233], v[234:235]
    v_pk_add_f32 v[194:195], v[236:237], v[238:239]
    s_mov_b32 exec_lo, -1
    s_nop 0
    v_permlane16_swap_b32 v192, v194
    v_permlane16_swap_b32 v193, v195
    v_and_b32 v192, -2, v192
    v_and_b32 v193, -2, v193
    v_and_b32 v194, -2, v194
    v_and_b32 v195, -2, v195
    s_cmp_lg_u32 s98, 1
    s_cbranch_scc1 L_hs23a
    buffer_store_dwordx4 v[192:195], v28, s[44:47], s74 offen
L_hs23b:
    s_mov_b64 exec, -1
    s_cmp_ge_u32 s4, 28
    s_cbranch_scc1 L_sdone
    s_barrier
    v_mov_b32 v224, 0
    v_mov_b32 v225, 0
    v_mov_b32 v226, 0
    v_mov_b32 v227, 0
    v_mov_b32 v228, 0
    v_mov_b32 v229, 0
    v_mov_b32 v230, 0
    v_mov_b32 v231, 0
    v_mov_b32 v232, 0
    v_mov_b32 v233, 0
    v_mov_b32 v234, 0
    v_mov_b32 v235, 0
    v_mov_b32 v236, 0
    v_mov_b32 v237, 0
    v_mov_b32 v238, 0
    v_mov_b32 v239, 0
    v_mov_b32 v212, 0
    v_mov_b32 v213, 0
    v_mov_b32 v214, 0
    v_mov_b32 v215, 0
    s_nop 0
    s_branch L_ln2
L_rstage:
    s_cmp_ge_u32 s4, 28
    s_cbranch_scc1 L_sdone
    s_add_u32 s8, s75, 4096
    s_barrier
    s_mov_b32 s15, 0
L_ga24:
    buffer_load_dwordx4 v[184:187], v24, s[44:47], s75 offen offset:0 sc1
    buffer_load_dwordx4 v[188:191], v24, s[44:47], s75 offen offset:1024 sc1
    buffer_load_dwordx4 v[192:195], v24, s[44:47], s75 offen offset:2048 sc1
    buffer_load_dwordx4 v[196:199], v24, s[44:47], s75 offen offset:3072 sc1
    buffer_load_dwordx4 v[200:203], v24, s[44:47], s8 offen offset:0 sc1
    buffer_load_dwordx4 v[204:207], v24, s[44:47], s8 offen offset:1024 sc1
    buffer_load_dwordx4 v[208:211], v24, s[44:47], s8 offen offset:2048 sc1
    buffer_load_dwordx4 v[212:215], v24, s[44:47], s8 offen offset:3072 sc1
    s_add_u32 s15, s15, 1
    s_cmp_lt_u32 s15, 1000000
    s_cselect_b64 s[96:97], -1, 0
    s_waitcnt vmcnt(6)
    v_pk_add_f32 v[216:217], v[184:185], v[188:189]
    v_pk_add_f32 v[218:219], v[186:187], v[190:191]
    v_bitop3_b32 v3, v184, v185, v186 bitop3:0xfe
    v_bitop3_b32 v3, v186, v187, v3 bitop3:0xfe
    v_bitop3_b32 v3, v188, v189, v3 bitop3:0xfe
    v_bitop3_b32 v3, v190, v191, v3 bitop3:0xfe
    s_waitcnt vmcnt(5)
    v_bitop3_b32 v3, v192, v193, v3 bitop3:0xfe
    v_bitop3_b32 v3, v194, v195, v3 bitop3:0xfe
    v_pk_add_f32 v[216:217], v[216:217], v[192:193]
    v_pk_add_f32 v[218:219], v[218:219], v[194:195]
    s_waitcnt vmcnt(4)
    v_bitop3_b32 v3, v196, v197, v3 bitop3:0xfe
    v_bitop3_b32 v3, v198, v199, v3 bitop3:0xfe
    v_pk_add_f32 v[216:217], v[216:217], v[196:197]
    v_pk_add_f32 v[218:219], v[218:219], v[198:199]
    s_waitcnt vmcnt(3)
    v_bitop3_b32 v3, v200, v201, v3 bitop3:0xfe
    v_bitop3_b32 v3, v202, v203, v3 bitop3:0xfe
    v_pk_add_f32 v[216:217], v[216:217], v[200:201]
    v_pk_add_f32 v[218:219], v[218:219], v[202:203]
    s_waitcnt vmcnt(2)
    v_bitop3_b32 v3, v204, v205, v3 bitop3:0xfe
    v_bitop3_b32 v3, v206, v207, v3 bitop3:0xfe
    v_pk_add_f32 v[216:217], v[216:217], v[204:205]
    v_pk_add_f32 v[218:219], v[218:219], v[206:207]
    s_waitcnt vmcnt(1)
    v_bitop3_b32 v3, v208, v209, v3 bitop3:0xfe
    v_bitop3_b32 v3, v210, v211, v3 bitop3:0xfe
    v_pk_add_f32 v[216:217], v[216:217], v[208:209]
    v_pk_add_f32 v[218:219], v[218:219], v[210:211]
    s_waitcnt vmcnt(0)
    v_bitop3_b32 v3, v212, v213, v3 bitop3:0xfe
    v_bitop3_b32 v3, v214, v215, v3 bitop3:0xfe
    v_pk_add_f32 v[216:217], v[216:217], v[212:213]
    v_pk_add_f32 v[218:219], v[218:219], v[214:215]
    v_and_b32 v3, 1, v3
    s_nop 0
    v_permlane32_swap_b32 v216, v218
    v_permlane32_swap_b32 v217, v219
    v_cmp_ne_u32 vcc, 0, v3
    v_pk_add_f32 v[216:217], v[216:217], v[218:219]
    s_and_b64 vcc, vcc, s[96:97]
    s_cbranch_scc1 L_ga24
    v_permlane16_swap_b32 v216, v217
    v_add_f32 v13, v216, v217
    v_cvt_pk_bf16_f32 v13, 0, v13
    v_mul_f32 v13, v13, v240
    v_cvt_pk_bf16_f32 v13, 0, v13
    v_add_f32 v13, v13, v241
    s_nop 1
    v_mov_b32_dpp v14, v13 quad_perm:[1,1,3,3] row_mask:0xf bank_mask:0xf
    v_cvt_pk_bf16_f32 v12, v13, v14
    v_min_u32 v12, -2, v12
    s_mov_b32 exec_lo, 0x55555555
    s_mov_b32 exec_hi, 0x55555555
    s_cmp_lg_u32 s98, 1
    s_cbranch_scc1 L_hs25a
    buffer_store_dword v12, v25, s[44:47], s77 offen
L_hs25b:
    s_mov_b64 exec, -1
    v_cvt_pk_bf16_f32 v241, 0, v13
L_ln2:
    s_mov_b32 s15, 0
    s_barrier
    s_cmp_lt_u32 s3, 4
    s_cbranch_scc0 L_ln7
    s_mov_b32 s15, 0
L_poll26:
    buffer_load_dwordx4 v[184:187], v30, s[44:47], s76 offen sc1
    s_add_u32 s15, s15, 1
    s_cmp_lt_u32 s15, 1000000
    s_cselect_b64 s[96:97], -1, 0
    s_waitcnt vmcnt(0)
    v_max_u32 v3, v184, v185
    v_max3_u32 v3, v3, v186, v187
    v_cmp_eq_u32 vcc, -1, v3
    s_and_b64 vcc, vcc, s[96:97]
    s_cbranch_scc1 L_poll26
    v_readfirstlane_b32 s11, v184
    v_lshlrev_b32 v192, 16, v184
    v_and_b32 v193, 0xffff0000, v184
    v_lshlrev_b32 v194, 16, v185
    v_and_b32 v195, 0xffff0000, v185
    v_lshlrev_b32 v196, 16, v186
    v_and_b32 v197, 0xffff0000, v186
    v_lshlrev_b32 v198, 16, v187
    v_and_b32 v199, 0xffff0000, v187
    s_lshl_b32 s11, s11, 16
    v_mov_b32 v10, s11
    v_pk_add_f32 v[200:201], v[192:193], v[10:11] op_sel_hi:[1,0] neg_lo:[0,1] neg_hi:[0,1]
    v_pk_add_f32 v[202:203], v[194:195], v[10:11] op_sel_hi:[1,0] neg_lo:[0,1] neg_hi:[0,1]
    v_pk_add_f32 v[204:205], v[196:197], v[10:11] op_sel_hi:[1,0] neg_lo:[0,1] neg_hi:[0,1]
    v_pk_add_f32 v[206:207], v[198:199], v[10:11] op_sel_hi:[1,0] neg_lo:[0,1] neg_hi:[0,1]
    v_pk_add_f32 v[12:13], v[200:201], v[202:203]
    v_pk_mul_f32 v[14:15], v[200:201], v[200:201]
    v_pk_add_f32 v[10:11], v[204:205], v[206:207]
    v_pk_fma_f32 v[14:15], v[202:203], v[202:203], v[14:15]
    v_pk_add_f32 v[12:13], v[12:13], v[10:11]
    v_pk_fma_f32 v[14:15], v[204:205], v[204:205], v[14:15]
    v_pk_fma_f32 v[14:15], v[206:207], v[206:207], v[14:15]
    v_add_f32 v10, v12, v13
    v_add_f32 v12, v14, v15
    v_cndmask_b32 v10, 0, v10, s[64:65]
    v_cndmask_b32 v12, 0, v12, s[64:65]
    s_nop 1
    v_permlane32_swap_b32 v10, v12
    v_add_f32 v10, v10, v12
    v_mov_b32 v12, v10
    s_nop 1
    v_permlane16_swap_b32 v10, v12
    v_add_f32 v10, v10, v12
    s_nop 1
    v_add_f32_dpp v10, v10, v10 row_ror:8 row_mask:0xf bank_mask:0xf
    s_nop 1
    v_add_f32_dpp v10, v10, v10 row_ror:4 row_mask:0xf bank_mask:0xf
    s_nop 1
    v_add_f32_dpp v10, v10, v10 row_ror:2 row_mask:0xf bank_mask:0xf
    s_nop 1
    v_add_f32_dpp v10, v10, v10 row_ror:1 row_mask:0xf bank_mask:0xf
    v_mul_f32 v10, 0x3b124925, v10
    v_mov_b32 v12, v10
    s_nop 1
    v_permlane32_swap_b32 v10, v12
    v_fma_f32 v12, -v10, v10, v12
    v_add_f32 v10, s11, v10
    v_max_f32 v12, 0, v12
    v_cvt_pk_bf16_f32 v10, 0, v10
    v_cvt_pk_bf16_f32 v12, 0, v12
    v_add_f32 v12, 0x3727c5ac, v12
    v_pk_add_f32 v[192:193], v[192:193], v[10:11] op_sel_hi:[1,0] neg_lo:[0,1] neg_hi:[0,1]
    v_pk_add_f32 v[194:195], v[194:195], v[10:11] op_sel_hi:[1,0] neg_lo:[0,1] neg_hi:[0,1]
    v_cvt_pk_bf16_f32 v12, 0, v12
    v_sqrt_f32 v12, v12
    v_pk_add_f32 v[196:197], v[196:197], v[10:11] op_sel_hi:[1,0] neg_lo:[0,1] neg_hi:[0,1]
    v_pk_add_f32 v[198:199], v[198:199], v[10:11] op_sel_hi:[1,0] neg_lo:[0,1] neg_hi:[0,1]
    v_cvt_pk_bf16_f32 v192, 0, v192
    v_cvt_pk_bf16_f32 v193, 0, v193
    v_cvt_pk_bf16_f32 v12, 0, v12
    v_rcp_f32 v12, v12
    v_cvt_pk_bf16_f32 v194, 0, v194
    v_cvt_pk_bf16_f32 v195, 0, v195
    v_cvt_pk_bf16_f32 v196, 0, v196
    v_cvt_pk_bf16_f32 v197, 0, v197
    v_cvt_pk_bf16_f32 v198, 0, v198
    v_cvt_pk_bf16_f32 v199, 0, v199
    v_pk_mul_f32 v[192:193], v[192:193], v[12:13] op_sel_hi:[1,0]
    v_pk_mul_f32 v[194:195], v[194:195], v[12:13] op_sel_hi:[1,0]
    v_pk_mul_f32 v[196:197], v[196:197], v[12:13] op_sel_hi:[1,0]
    v_pk_mul_f32 v[198:199], v[198:199], v[12:13] op_sel_hi:[1,0]
    v_cvt_pk_bf16_f32 v192, 0, v192
    v_cvt_pk_bf16_f32 v193, 0, v193
    v_cvt_pk_bf16_f32 v194, 0, v194
    v_cvt_pk_bf16_f32 v195, 0, v195
    v_cvt_pk_bf16_f32 v196, 0, v196
    v_cvt_pk_bf16_f32 v197, 0, v197
    v_cvt_pk_bf16_f32 v198, 0, v198
    v_cvt_pk_bf16_f32 v199, 0, v199
    v_pk_mul_f32 v[192:193], v[192:193], v[240:241]
    v_pk_mul_f32 v[194:195], v[194:195], v[242:243]
    v_pk_mul_f32 v[196:197], v[196:197], v[244:245]
    v_pk_mul_f32 v[198:199], v[198:199], v[246:247]
    v_cvt_pk_bf16_f32 v192, 0, v192
    v_cvt_pk_bf16_f32 v193, 0, v193
    v_cvt_pk_bf16_f32 v194, 0, v194
    v_cvt_pk_bf16_f32 v195, 0, v195
    v_cvt_pk_bf16_f32 v196, 0, v196
    v_cvt_pk_bf16_f32 v197, 0, v197
    v_cvt_pk_bf16_f32 v198, 0, v198
    v_cvt_pk_bf16_f32 v199, 0, v199
    v_pk_add_f32 v[192:193], v[192:193], v[248:249]
    v_pk_add_f32 v[194:195], v[194:195], v[250:251]
    v_pk_add_f32 v[196:197], v[196:197], v[252:253]
    v_pk_add_f32 v[198:199], v[198:199], v[254:255]
    v_cvt_pk_bf16_f32 v184, v192, v193
    v_cvt_pk_bf16_f32 v186, v194, v195
    v_cvt_pk_bf16_f32 v185, v196, v197
    v_cvt_pk_bf16_f32 v187, v198, v199
    ds_write2_b64 v23, v[184:185], v[186:187] offset0:0 offset1:2
L_f1b:
    v_mov_b32 v15, 0x3d372713
    s_waitcnt lgkmcnt(0)
    s_barrier
    ds_read_b128 v[184:187], v29 offset:0
    ds_read_b128 v[188:191], v29 offset:128
    ds_read_b128 v[192:195], v29 offset:256
    ds_read_b128 v[196:199], v29 offset:384
    ds_read_b128 v[200:203], v29 offset:512
    ds_read_b128 v[204:207], v29 offset:640
    ds_read_b128 v[208:211], v29 offset:768
    s_waitcnt lgkmcnt(6)
    v_smfmac_f32_16x16x64_bf16 v[212:215], v[184:187], v[96:103], v31
    s_waitcnt lgkmcnt(5)
    v_smfmac_f32_16x16x64_bf16 v[212:215], v[188:191], v[104:111], v31
    s_waitcnt lgkmcnt(4)
    v_smfmac_f32_16x16x64_bf16 v[212:215], v[192:195], v[112:119], v31
    s_waitcnt lgkmcnt(3)
    v_smfmac_f32_16x16x64_bf16 v[212:215], v[196:199], v[120:127], v31
    s_waitcnt lgkmcnt(2)
    v_smfmac_f32_16x16x64_bf16 v[212:215], v[200:203], v[128:135], v31
    s_waitcnt lgkmcnt(1)
    v_smfmac_f32_16x16x64_bf16 v[212:215], v[204:207], v[136:143], v31
    s_waitcnt lgkmcnt(0)
    v_smfmac_f32_16x16x64_bf16 v[212:215], v[208:211], v[144:151], v31
    s_nop 7
    v_pk_add_f32 v[12:13], v[212:213], v[214:215]
    s_mov_b32 exec_lo, 0
    v_mov_b32 v12, v13
    s_mov_b32 exec_lo, -1
    v_cvt_pk_bf16_f32 v12, 0, v12
    v_mul_f32 v14, v12, v12
    v_fma_f32 v14, v14, v15, 1.0
    v_mul_f32 v14, v14, v12
    v_mov_b32_dpp v13, v12 row_ror:8 row_mask:0xf bank_mask:0xf
    v_mul_f32 v14, 0xc0135761, v14
    v_exp_f32 v14, v14
    s_nop 0
    v_add_f32 v14, 1.0, v14
    v_rcp_f32 v14, v14
    s_nop 0
    v_mul_f32 v14, v14, v12
    v_cvt_pk_bf16_f32 v14, 0, v14
    v_mul_f32 v11, v14, v13
    v_cvt_pk_bf16_f32 v11, v11, v11
    s_mov_b32 exec_lo, 0x00ff00ff
    s_mov_b32 exec_hi, 0x00ff00ff
    ds_write_b16 v27, v11
    s_mov_b64 exec, -1
    s_waitcnt lgkmcnt(0)
    s_barrier
    s_cmp_eq_u32 s3, 7
    s_cbranch_scc1 L_r2
    ds_read_b128 v[184:187], v21 offset:0
    s_waitcnt lgkmcnt(0)
    v_smfmac_f32_16x16x64_bf16 v[224:227], v[184:187], v[152:159], v31
    v_smfmac_f32_16x16x64_bf16 v[228:231], v[184:187], v[160:167], v31
    v_smfmac_f32_16x16x64_bf16 v[232:235], v[184:187], v[168:175], v31
    v_smfmac_f32_16x16x64_bf16 v[236:239], v[184:187], v[176:183], v31
    s_nop 4
    v_pk_add_f32 v[192:193], v[224:225], v[226:227]
    v_pk_add_f32 v[194:195], v[228:229], v[230:231]
    s_mov_b32 exec_lo, 0
    v_pk_add_f32 v[192:193], v[232:233], v[234:235]
    v_pk_add_f32 v[194:195], v[236:237], v[238:239]
    s_mov_b32 exec_lo, -1
    s_nop 0
    v_permlane16_swap_b32 v192, v194
    v_permlane16_swap_b32 v193, v195
    v_or_b32 v192, 1, v192
    v_or_b32 v193, 1, v193
    v_or_b32 v194, 1, v194
    v_or_b32 v195, 1, v195
    s_cmp_lg_u32 s98, 1
    s_cbranch_scc1 L_hs27a
    buffer_store_dwordx4 v[192:195], v28, s[44:47], s74 offen
L_hs27b:
    s_mov_b64 exec, -1
    s_barrier
    s_branch L_sdone
L_r2:
    s_add_u32 s8, s75, 4096
    s_lshl_b32 s9, s4, 5
    s_barrier
    s_mov_b32 s15, 0
L_ga28:
    buffer_load_dwordx4 v[184:187], v24, s[44:47], s75 offen offset:0 sc1
    buffer_load_dwordx4 v[188:191], v24, s[44:47], s75 offen offset:1024 sc1
    buffer_load_dwordx4 v[192:195], v24, s[44:47], s75 offen offset:2048 sc1
    buffer_load_dwordx4 v[196:199], v24, s[44:47], s75 offen offset:3072 sc1
    buffer_load_dwordx4 v[200:203], v24, s[44:47], s8 offen offset:0 sc1
    buffer_load_dwordx4 v[204:207], v24, s[44:47], s8 offen offset:1024 sc1
    buffer_load_dwordx4 v[208:211], v24, s[44:47], s8 offen offset:2048 sc1
    s_add_u32 s15, s15, 1
    s_cmp_lt_u32 s15, 1000000
    s_cselect_b64 s[96:97], -1, 0
    s_waitcnt vmcnt(5)
    v_pk_add_f32 v[216:217], v[184:185], v[188:189]
    v_pk_add_f32 v[218:219], v[186:187], v[190:191]
    v_bitop3_b32 v3, v184, v185, v186 bitop3:0x80
    v_bitop3_b32 v3, v186, v187, v3 bitop3:0x80
    v_bitop3_b32 v3, v188, v189, v3 bitop3:0x80
    v_bitop3_b32 v3, v190, v191, v3 bitop3:0x80
    s_waitcnt vmcnt(4)
    v_bitop3_b32 v3, v192, v193, v3 bitop3:0x80
    v_bitop3_b32 v3, v194, v195, v3 bitop3:0x80
    v_pk_add_f32 v[216:217], v[216:217], v[192:193]
    v_pk_add_f32 v[218:219], v[218:219], v[194:195]
    s_waitcnt vmcnt(3)
    v_bitop3_b32 v3, v196, v197, v3 bitop3:0x80
    v_bitop3_b32 v3, v198, v199, v3 bitop3:0x80
    v_pk_add_f32 v[216:217], v[216:217], v[196:197]
    v_pk_add_f32 v[218:219], v[218:219], v[198:199]
    s_waitcnt vmcnt(2)
    v_bitop3_b32 v3, v200, v201, v3 bitop3:0x80
    v_bitop3_b32 v3, v202, v203, v3 bitop3:0x80
    v_pk_add_f32 v[216:217], v[216:217], v[200:201]
    v_pk_add_f32 v[218:219], v[218:219], v[202:203]
    s_waitcnt vmcnt(1)
    v_bitop3_b32 v3, v204, v205, v3 bitop3:0x80
    v_bitop3_b32 v3, v206, v207, v3 bitop3:0x80
    v_pk_add_f32 v[216:217], v[216:217], v[204:205]
    v_pk_add_f32 v[218:219], v[218:219], v[206:207]
    s_waitcnt vmcnt(0)
    v_bitop3_b32 v3, v208, v209, v3 bitop3:0x80
    v_bitop3_b32 v3, v210, v211, v3 bitop3:0x80
    v_pk_add_f32 v[216:217], v[216:217], v[208:209]
    v_pk_add_f32 v[218:219], v[218:219], v[210:211]
    v_and_b32 v3, 1, v3
    s_nop 0
    v_permlane32_swap_b32 v216, v218
    v_permlane32_swap_b32 v217, v219
    v_cmp_ne_u32 vcc, 1, v3
    v_pk_add_f32 v[216:217], v[216:217], v[218:219]
    s_and_b64 vcc, vcc, s[96:97]
    s_cbranch_scc1 L_ga28
    v_permlane16_swap_b32 v216, v217
    v_add_f32 v12, v216, v217
    v_cvt_pk_bf16_f32 v12, 0, v12
    v_mul_f32 v12, v12, v242
    v_cvt_pk_bf16_f32 v12, 0, v12
    v_add_f32 v12, v12, v241
    v_cvt_pk_bf16_f32 v12, v12, v12
    buffer_store_short v12, v26, s[56:59], s9 offen
L_sdone:
    s_endpgm
L_hs15a:
    buffer_store_dwordx4 v[12:15], v11, s[44:47], s8 offen offset:0 sc1
    buffer_store_dwordx4 v[12:15], v11, s[44:47], s8 offen offset:1024 sc1
    buffer_store_dwordx4 v[12:15], v11, s[44:47], s8 offen offset:2048 sc1
    buffer_store_dwordx4 v[12:15], v11, s[44:47], s8 offen offset:3072 sc1
    buffer_store_dwordx4 v[12:15], v11, s[44:47], s9 offen offset:0 sc1
    buffer_store_dwordx4 v[12:15], v11, s[44:47], s9 offen offset:1024 sc1
    buffer_store_dwordx4 v[12:15], v11, s[44:47], s9 offen offset:2048 sc1
    buffer_store_dwordx4 v[12:15], v11, s[44:47], s9 offen offset:3072 sc1
    s_nop 0
    s_branch L_hs15b
L_hs16a:
    buffer_store_dwordx4 v[12:15], v11, s[44:47], s8 offen sc1
    s_nop 0
    s_branch L_hs16b
L_hs23a:
    buffer_store_dwordx4 v[192:195], v28, s[44:47], s74 offen sc1
    s_nop 0
    s_branch L_hs23b
L_hs25a:
    buffer_store_dword v12, v25, s[44:47], s77 offen sc1
    s_branch L_hs25b
L_ln7:
    v_mov_b32 v212, 0
    v_mov_b32 v213, 0
    v_mov_b32 v214, 0
    v_mov_b32 v215, 0
    s_nop 0
    s_branch L_f1b
L_hs27a:
    buffer_store_dwordx4 v[192:195], v28, s[44:47], s74 offen sc1
    s_nop 0
    s_branch L_hs27b
L_end:
    s_endpgm
.section .rodata,"a"
.p2align 6
.amdhsa_kernel adaLN_cond__gqa_block_cached__geglu_ffn__decode_kernel
  .amdhsa_next_free_vgpr 256
  .amdhsa_next_free_sgpr 102
  .amdhsa_accum_offset 256
  .amdhsa_group_segment_fixed_size 0
  .amdhsa_kernarg_size 112
  .amdhsa_user_sgpr_count 2
  .amdhsa_user_sgpr_kernarg_segment_ptr 1
  .amdhsa_system_sgpr_workgroup_id_x 1
  .amdhsa_float_denorm_mode_32 3
  .amdhsa_float_denorm_mode_16_64 3
.end_amdhsa_kernel
```
